```python
import torch

def _softmax(x, axis=-1):
    return torch.softmax(x, dim=axis)
def _gelu(x):
    return torch.nn.functional.gelu(x, approximate="tanh")
def _silu(x):
    return torch.nn.functional.silu(x)
def _sigmoid(x):
    return torch.sigmoid(x)
def _layernorm(x, axis=-1, eps=1e-5):
    m = x.mean(dim=axis, keepdim=True)
    v = x.var(dim=axis, keepdim=True, unbiased=False)
    return (x - m) / torch.sqrt(v + eps)
def _scatter_add(tgt, idx, src, axis=0):
    return tgt.clone().index_add_(axis, idx, src)
def _segment_sum(src, seg, n):
    out = torch.zeros((n,) + src.shape[1:], dtype=src.dtype)
    return out.index_add_(0, seg, src)
def _pad(x, pw):
    flat = tuple(v for pair in reversed(pw) for v in pair)
    return torch.nn.functional.pad(x, flat)

kernel_name = 'gated_mix__ssm_conv_s4__dense_activation_relu__prompt'

def setup_inputs():

    _w = (lambda a: (lambda t: t.to(torch.bfloat16) if t.is_floating_point() else t)(torch.as_tensor(a)))
    def _A_setup():
        B, L, D, N = 1, 2048, 512, 128
        A_re = -(lambda _x: torch.exp(torch.as_tensor(_x)))((lambda *s: torch.randn(*s, dtype=torch.bfloat16) * 3.2)(D, N))
        A_im = torch.pi * (lambda *s: torch.randn(*s, dtype=torch.bfloat16) * 0.2)(D, N)
        B_re = (lambda *s: torch.randn(*s, dtype=torch.bfloat16) * 0.4)(D, N)
        B_im = (lambda *s: torch.randn(*s, dtype=torch.bfloat16) * 0.4)(D, N)
        C_re = (lambda *s: torch.randn(*s, dtype=torch.bfloat16) * 0.4)(D, N)
        C_im = (lambda *s: torch.randn(*s, dtype=torch.bfloat16) * 0.4)(D, N)
        log_dt = (lambda *s: torch.randn(*s, dtype=torch.bfloat16) * 0.2)(D) * 0.5 - 4.0
        Dskip = (lambda *s: torch.randn(*s, dtype=torch.bfloat16) * 0.4)(D)
        return {
            "u": _w((lambda *s: torch.randn(*s, dtype=torch.bfloat16) * 0.05)(B, L, D)),
            "A_re": _w(A_re),
            "A_im": _w(A_im),
            "B_re": _w(B_re),
            "B_im": _w(B_im),
            "C_re": _w(C_re),
            "C_im": _w(C_im),
            "log_dt": _w(log_dt),
            "Dskip": _w(Dskip),
        }
    _A_in = _A_setup()

    def _B_setup():
        B, S, D, Dff = 1, 2048, 512, 1792
        return {
            "x": _w((lambda *s: torch.randn(*s, dtype=torch.bfloat16) * 0.05)(B, S, D)),
            "w1": _w((lambda *s: torch.randn(*s, dtype=torch.bfloat16) * 0.05)(D, Dff)),
            "w2": _w((lambda *s: torch.randn(*s, dtype=torch.bfloat16) * 0.05)(Dff, D)),
        }
    _B_in = _B_setup()

    return {
        "A_u": _A_in["u"],
        "A_A_re": _A_in["A_re"],
        "A_A_im": _A_in["A_im"],
        "A_B_re": _A_in["B_re"],
        "A_B_im": _A_in["B_im"],
        "A_C_re": _A_in["C_re"],
        "A_C_im": _A_in["C_im"],
        "A_log_dt": _A_in["log_dt"],
        "A_Dskip": _A_in["Dskip"],
        "B_x": _B_in["x"],
        "B_w1": _B_in["w1"],
        "B_w2": _B_in["w2"],
        "gate_w": _w((lambda *s: torch.randn(*s, dtype=torch.bfloat16) * 0.05)(512) * 16.0),
    }

def reference(A_u, A_A_re, A_A_im, A_B_re, A_B_im, A_C_re, A_C_im, A_log_dt, A_Dskip, B_x, B_w1, B_w2, gate_w):
    def _A_ref(u, A_re, A_im, B_re, B_im, C_re, C_im, log_dt, Dskip):
        Bsz, L, D = u.shape
        dt = torch.exp(log_dt)[:, None]
        A = A_re + 1j * A_im
        Bc = B_re + 1j * B_im
        Cc = C_re + 1j * C_im
        logdA = dt * A
        dB = dt * Bc
        l = (lambda x, dt: x.to(dt))(torch.arange(L), A_re.dtype)
        P = torch.exp(logdA[:, :, None] * l[None, None, :])
        K = torch.einsum("dn,dnl,dn->dl", Cc, P, dB).real
        L2 = 2 * L
        Kp = _pad(K, ((0, 0), (0, L)))
        up = (lambda x, *d: x.permute(*d))(u, 0, 2, 1)
        up = _pad(up, ((0, 0), (0, 0), (0, L)))
        Kf = (lambda x, axes=(-2,-1): torch.fft.rfft2(x.float(), dim=axes))(Kp[:, None, :], axes=(-2, -1))
        Uf = (lambda x, axes=(-2,-1): torch.fft.rfft2(x.float(), dim=axes))(up[:, :, None, :], axes=(-2, -1))
        Yf = Uf * Kf[None, :, :, :]
        y = (lambda x, s, axes=(-2,-1): torch.fft.irfft2(x, s=s, dim=axes).to(torch.bfloat16))(Yf, (1, L2), axes=(-2, -1))[:, :, 0, :L]
        y = (lambda x, *d: x.permute(*d))(y, 0, 2, 1) + u * Dskip[None, None, :]
        return y

    def _B_ref(x, w1, w2):
        h = torch.einsum("bsd,df->bsf", x, w1)
        zero = torch.zeros_like(h)
        h = torch.maximum(h, zero)
        return torch.einsum("bsf,fd->bsd", h, w2)

    x = A_u
    g = _sigmoid((x * gate_w).sum(-1, keepdims=True))
    a = _A_ref(x, A_A_re, A_A_im, A_B_re, A_B_im, A_C_re, A_C_im, A_log_dt, A_Dskip)
    b = _B_ref(x, B_w1, B_w2)
    return g * a + (1 - g) * b
```

```asm
; @launch grid=(256,1,1) block=(512,1,1) lds=163840
.amdgcn_target "amdgcn-amd-amdhsa--gfx950"
.text
.globl gated_mix__ssm_conv_s4__dense_activation_relu__prompt_kernel
.p2align 8
.type gated_mix__ssm_conv_s4__dense_activation_relu__prompt_kernel,@function
gated_mix__ssm_conv_s4__dense_activation_relu__prompt_kernel:
    s_cmp_ge_u32 s2, 256
    s_cbranch_scc1 L_exit
    s_load_dwordx16 s[16:31], s[0:1], 0
    s_load_dwordx16 s[32:47], s[0:1], 64
    s_getpc_b64 s[66:67]
L_pc:
    s_lshr_b32 s5, s2, 3
    s_lshl_b32 s64, s5, 11
    v_lshl_add_u32 v2, v0, 2, s64
    v_min_u32 v2, L_exit-L_pc, v2
    v_mov_b32 v3, 0
    v_lshrrev_b32 v1, 6, v0
    v_lshl_add_u64 v[2:3], v[2:3], 0, s[66:67]
    v_readfirstlane_b32 s3, v1
    global_load_dword v15, v[2:3], off
    v_and_b32 v0, 63, v0
    s_and_b32 s4, s2, 7
    s_and_b32 s64, s5, 3
    s_lshr_b32 s9, s5, 2
    s_lshl2_add_u32 s8, s4, s64
    s_and_b32 s65, s4, 1
    s_mul_i32 s65, s65, 7
    s_add_u32 s7, s65, s9
    s_add_u32 s11, s64, s9
    s_and_b32 s11, s11, 3
    s_lshl_b32 s11, s11, 1
    s_lshr_b32 s12, s9, 2
    s_add_u32 s12, s12, s11
    s_cmp_eq_u32 s12, 3
    s_cmov_b32 s12, 2
    s_and_b32 s65, s9, 3
    s_cmp_eq_u32 s65, 3
    s_cselect_b32 s65, 4, 0
    s_xor_b32 s9, s9, s65
    s_cmp_lt_u32 s5, 28
    s_cselect_b32 s14, 1, 0
    v_lshlrev_b32 v20, 2, v0
    v_add_u32 v21, 163104, v20
    v_mov_b32 v22, 1
    ds_write_b32 v21, v22
    v_cmp_gt_u32 vcc, 16, v0
    v_and_b32 v11, 7, v0
    v_lshlrev_b32 v19, 4, v11
    v_cndmask_b32 v22, 0, 1, vcc
    s_mov_b64 exec, 0xffffff
    ds_write_b32 v21, v22 offset:256
    s_mov_b64 exec, -1
    s_lshr_b32 s65, s4, 1
    s_lshl2_add_u32 s6, s65, s64
    s_lshl_b32 s10, s4, 5
    s_add_u32 s10, s10, s5
    s_and_b32 s15, s3, 1
    s_lshl1_add_u32 s71, s10, s15
    s_lshl_b32 s64, s71, 8
    v_add_u32 v1, s64, v20
    s_lshl_b32 s64, s71, 1
    v_mov_b32 v23, s64
    s_lshl_b32 s65, s9, 7
    v_add_u32 v24, s65, v19
    v_lshrrev_b32 v18, 3, v0
    v_lshl_add_u32 v18, v18, 10, v19
    v_add_u32 v19, 7168, v18
    s_lshl2_add_u32 s66, s8, s3
    s_lshl_b32 s66, s66, 14
    s_add_u32 s66, s66, s65
    s_lshl_b32 s72, s3, 12
    s_add_u32 m0, s72, 98304
    s_mov_b32 s50, 0x200000
    s_mov_b32 s51, 0x20000
    v_bfe_u32 v9, v0, 2, 3
    v_lshlrev_b32 v9, 12, v9
    v_lshrrev_b32 v10, 5, v0
    v_lshl_add_u32 v9, v10, 6, v9
    v_and_b32 v25, 3, v0
    v_lshl_add_u32 v9, v25, 4, v9
    s_lshl2_add_u32 s64, s6, s3
    s_lshl_b32 s64, s64, 15
    v_add_u32 v8, s64, v9
    s_mov_b32 s68, s12
    s_lshl_b32 s67, s68, 7
    s_waitcnt lgkmcnt(0)
    s_cmp_lt_u32 s3, 4
    s_cbranch_scc1 L_Gh
    global_load_dword v2, v1, s[18:19]
    global_load_dword v3, v1, s[20:21]
    global_load_dword v4, v1, s[22:23]
    global_load_dword v5, v1, s[24:25]
    global_load_dword v6, v1, s[26:27]
    global_load_dword v7, v1, s[28:29]
    global_load_ushort v8, v23, s[30:31]
    global_load_ushort v13, v23, s[32:33]
    global_load_dwordx4 v[252:255], v24, s[40:41]
    s_barrier
    s_load_dword s74, s[46:47], 0
    s_branch L_Ab
L_Gh:
    s_mov_b64 s[48:49], s[16:17]
    s_mov_b32 s18, s67
    v_mov_b32 v11, v25
    v_lshrrev_b32 v16, 4, v0
    v_bfe_u32 v12, v0, 2, 2
    v_xor_b32 v17, v12, v16
    v_lshlrev_b32 v17, 6, v17
    v_lshl_add_u32 v17, v11, 4, v17
    s_lshl_b32 s64, s7, 8
    s_mul_i32 s65, s3, 57344
    s_add_u32 s64, s64, s65
    v_mul_u32_u24 v16, 3584, v16
    v_add3_u32 v152, v16, v17, s64
    s_barrier
    buffer_load_dwordx4 v18, s[48:51], s66 offen lds
    buffer_load_dwordx4 v19, s[48:51], s66 offen offset:1024 lds
    s_load_dword s74, s[46:47], 0
    s_mov_b32 s60, s36
    s_mov_b32 s61, s37
    s_mov_b32 s62, 0x1c0000
    s_mov_b32 s63, 0x20000
    s_mov_b32 s52, s44
    s_mov_b32 s53, s45
    s_mov_b32 s54, 0x100
    s_mov_b32 s55, 0x20000
    s_cmp_eq_u32 s14, 0
    s_cbranch_scc1 L_Gn
    buffer_load_dwordx4 v[160:163], v8, s[48:51], s18 offen offset:0
    v_add_u32 v153, 13312, v152
    v_add_u32 v154, 26624, v152
    v_add_u32 v155, 39936, v152
    s_mul_i32 s68, s68, 229376
    s_lshl2_add_u32 s73, s3, 163104
    s_add_u32 m0, s72, 0
    s_nop 0
    buffer_load_dwordx4 v152, s[60:63], s68 offen offset:0 lds
    buffer_load_dwordx4 v[164:167], v8, s[48:51], s18 offen offset:1024
    buffer_load_dwordx4 v153, s[60:63], s68 offen offset:1024 lds
    buffer_load_dwordx4 v[168:171], v8, s[48:51], s18 offen offset:2048
    buffer_load_dwordx4 v154, s[60:63], s68 offen offset:2048 lds
    buffer_load_dwordx4 v[172:175], v8, s[48:51], s18 offen offset:3072
    buffer_load_dwordx4 v155, s[60:63], s68 offen offset:3072 lds
    s_mov_b32 m0, s73
    s_mov_b64 exec, 1
    buffer_load_dword off, s[52:55], 0 lds
    s_mov_b64 exec, -1
    s_xor_b32 s64, s12, 1
    s_mul_i32 s69, s64, 229376
    s_lshl_b32 s19, s64, 7
L_G:
    s_setprio 1
    s_mov_b64 s[0:1], s[38:39]
    s_mov_b64 s[16:17], s[42:43]
    s_mov_b32 s56, s46
    s_mov_b32 s57, s47
    s_mov_b32 s58, 0x1000000
    s_mov_b32 s59, 0x20000
    v_bfe_u32 v13, v0, 4, 1
    v_lshlrev_b32 v13, 5, v13
    v_lshl_add_u32 v13, v11, 3, v13
    v_lshl_add_u32 v18, v10, 3, v12
    v_lshl_add_u32 v18, v18, 7, v13
    s_add_u32 s64, s72, 98304
    v_add_u32 v18, s64, v18
    v_lshlrev_b32 v19, 4, v11
    v_bfe_u32 v17, v0, 2, 3
    v_lshl_add_u32 v19, v17, 7, v19
    v_lshl_add_u32 v19, v10, 6, v19
    s_lshl_b32 s64, s9, 5
    s_add_u32 s64, s64, s8
    s_lshl2_add_u32 s64, s64, s3
    s_lshl_b32 s45, s64, 11
    s_add_u32 s45, s45, 1048576
    s_add_u32 s64, s11, 2
    s_and_b32 s64, s64, 7
    s_lshl_b32 s20, s64, 7
    s_add_u32 s64, s11, 3
    s_and_b32 s64, s64, 7
    s_lshl_b32 s21, s64, 7
    s_add_u32 s64, s11, 4
    s_and_b32 s64, s64, 7
    s_lshl_b32 s22, s64, 7
    s_add_u32 s64, s11, 5
    s_and_b32 s64, s64, 7
    s_lshl_b32 s23, s64, 7
    s_add_u32 s64, s11, 6
    s_and_b32 s64, s64, 7
    s_lshl_b32 s24, s64, 7
    s_add_u32 s64, s11, 7
    s_and_b32 s64, s64, 7
    s_lshl_b32 s25, s64, 7
    v_mov_b32 v1, 163104
    s_lshl2_add_u32 s75, s3, 163232
    v_mov_b32 v2, s75
    v_lshlrev_b32 v3, 4, v0
    s_lshl_b32 s15, s3, 13
    v_lshl_add_u32 v9, v10, 5, v12
    v_lshl_add_u32 v9, v9, 8, v13
    v_lshl_add_u32 v128, v12, 6, v9
    v_xor_b32 v129, 64, v128
    v_xor_b32 v130, 128, v128
    v_xor_b32 v131, 192, v128
    v_add_u32 v132, 0x10000, v128
    v_add_u32 v133, 0x10000, v129
    v_add_u32 v134, 0x10000, v130
    v_add_u32 v135, 0x10000, v131
    s_mov_b32 s26, 0x55555555
    s_mov_b32 s27, s26
    s_mov_b32 s28, 0xaaaaaaaa
    s_mov_b32 s29, s28
    s_mov_b32 s30, 0x33333333
    s_mov_b32 s31, s30
    s_mov_b32 s32, 0xcccccccc
    s_mov_b32 s33, s32
    s_cmp_eq_u32 s14, 0
    s_cbranch_scc1 L_G_nog1
    s_add_u32 m0, s72, 16384
    s_nop 0
    buffer_load_dwordx4 v152, s[60:63], s69 offen offset:0 lds
    buffer_load_dwordx4 v153, s[60:63], s69 offen offset:1024 lds
    buffer_load_dwordx4 v154, s[60:63], s69 offen offset:2048 lds
    buffer_load_dwordx4 v155, s[60:63], s69 offen offset:3072 lds
    s_add_u32 m0, s73, 16
    s_mov_b64 exec, 1
    buffer_load_dword off, s[52:55], 0 lds
    s_mov_b64 exec, -1
    s_waitcnt vmcnt(14)
    ds_read_b64_tr_b16 v[20:21], v18 offset:0
    ds_read_b64_tr_b16 v[22:23], v18 offset:512
    ds_read_b64_tr_b16 v[24:25], v18 offset:64
    ds_read_b64_tr_b16 v[26:27], v18 offset:576
    s_waitcnt lgkmcnt(0)
    buffer_store_dwordx4 v[20:23], v19, s[56:59], s45 offen offset:0 sc1
    buffer_store_dwordx4 v[24:27], v19, s[56:59], s45 offen offset:1024 sc1
    buffer_load_dwordx4 v[176:179], v8, s[48:51], s19 offen offset:0
    buffer_load_dwordx4 v[180:183], v8, s[48:51], s19 offen offset:1024
    buffer_load_dwordx4 v[184:187], v8, s[48:51], s19 offen offset:2048
    buffer_load_dwordx4 v[188:191], v8, s[48:51], s19 offen offset:3072
    s_mul_i32 s13, s74, 1664525
    s_add_u32 s13, s13, 1013904223
    v_lshl_add_u32 v9, v10, 2, v12
    v_lshl_add_u32 v9, v9, 7, v13
    v_lshrrev_b32 v12, 1, v12
    v_lshl_add_u32 v9, v12, 6, v9
    v_add_u32 v140, s15, v9
    v_xor_b32 v141, 64, v140
    v_add_u32 v142, 0x10000, v140
    v_add_u32 v143, 0x10000, v141
    v_lshrrev_b32 v16, 3, v0
    v_and_b32 v17, 7, v0
    v_bfe_u32 v9, v0, 4, 1
    v_lshlrev_b32 v9, 2, v9
    v_xor_b32 v9, v17, v9
    v_lshlrev_b32 v9, 4, v9
    v_lshl_add_u32 v9, v16, 10, v9
    s_mul_i32 s64, s3, 458752
    s_lshl_b32 s65, s9, 7
    s_add_u32 s64, s64, s65
    v_add_u32 v144, s64, v9
    v_add_u32 v145, 7168, v144
    v_add_u32 v146, 14336, v144
    v_add_u32 v147, 21504, v144
    s_lshr_b32 s64, s3, 1
    s_lshl1_add_u32 s64, s6, s64
    s_and_b32 s65, s3, 1
    s_lshl1_add_u32 s66, s7, s65
    s_lshl_b32 s35, s64, 7
    s_lshl2_add_u32 s35, s66, s35
    s_add_u32 s35, s35, 40960
    s_mul_i32 s71, s64, 229376
    s_lshl_b32 s66, s7, 14
    s_add_u32 s71, s71, s66
    s_lshl_b32 s65, s65, 10
    s_add_u32 s71, s71, s65
    s_add_u32 s71, s71, 6291456
    s_mul_i32 s64, s3, 7
    s_and_b32 s64, s64, 30
    s_lshl_b32 s65, s8, 5
    s_add_u32 s64, s64, s65
    s_lshl2_add_u32 s64, s64, 40960
    v_lshl_add_u32 v10, v17, 2, s64
    v_add_u32 v14, 4096, v3
    s_and_b32 s65, s9, 3
    s_lshl_b32 s65, s65, 12
    s_add_u32 s44, s64, s65
    s_mul_i32 s64, s8, 229376
    s_mul_i32 s65, s3, 57344
    s_add_u32 s64, s64, s65
    s_add_u32 s64, s64, 6291456
    v_add_u32 v12, s64, v3
    v_add_u32 v13, s64, v14
    s_cmp_eq_u32 s4, 7
    s_cselect_b32 s12, 0, s4
    s_lshl_b32 s38, s12, 13
    s_add_u32 s39, s38, 8192
    s_cmp_eq_u32 s39, 57344
    s_cmov_b32 s39, 0
    s_add_u32 s40, s39, 8192
    s_cmp_eq_u32 s40, 57344
    s_cmov_b32 s40, 0
    s_add_u32 s41, s40, 8192
    s_cmp_eq_u32 s41, 57344
    s_cmov_b32 s41, 0
    s_add_u32 s42, s41, 8192
    s_cmp_eq_u32 s42, 57344
    s_cmov_b32 s42, 0
    s_add_u32 s43, s42, 8192
    s_cmp_eq_u32 s43, 57344
    s_cmov_b32 s43, 0
    s_add_u32 s34, s43, 8192
    s_cmp_eq_u32 s34, 57344
    s_cmov_b32 s34, 0
    s_mul_i32 s64, s3, 7
    s_and_b32 s64, s64, 1
    s_mov_b32 s36, 0
    s_lshr_b32 s65, s38, 13
    s_add_u32 s65, s65, s64
    s_lshr_b32 s65, s65, 1
    s_bitset1_b32 s36, s65
    s_lshr_b32 s65, s39, 13
    s_add_u32 s65, s65, s64
    s_lshr_b32 s65, s65, 1
    s_bitset1_b32 s36, s65
    s_waitcnt vmcnt(13)
    s_mov_b64 vcc, s[26:27]
    v_cndmask_b32_dpp v112, v164, v160, vcc quad_perm:[1,0,3,2] row_mask:0xf bank_mask:0xf
    v_cndmask_b32_dpp v113, v165, v161, vcc quad_perm:[1,0,3,2] row_mask:0xf bank_mask:0xf
    v_cndmask_b32_dpp v114, v166, v162, vcc quad_perm:[1,0,3,2] row_mask:0xf bank_mask:0xf
    v_cndmask_b32_dpp v115, v167, v163, vcc quad_perm:[1,0,3,2] row_mask:0xf bank_mask:0xf
    v_cndmask_b32_dpp v120, v172, v168, vcc quad_perm:[1,0,3,2] row_mask:0xf bank_mask:0xf
    v_cndmask_b32_dpp v121, v173, v169, vcc quad_perm:[1,0,3,2] row_mask:0xf bank_mask:0xf
    v_cndmask_b32_dpp v122, v174, v170, vcc quad_perm:[1,0,3,2] row_mask:0xf bank_mask:0xf
    v_cndmask_b32_dpp v123, v175, v171, vcc quad_perm:[1,0,3,2] row_mask:0xf bank_mask:0xf
    s_mov_b64 vcc, s[28:29]
    v_cndmask_b32_dpp v116, v160, v164, vcc quad_perm:[1,0,3,2] row_mask:0xf bank_mask:0xf
    v_cndmask_b32_dpp v117, v161, v165, vcc quad_perm:[1,0,3,2] row_mask:0xf bank_mask:0xf
    v_cndmask_b32_dpp v118, v162, v166, vcc quad_perm:[1,0,3,2] row_mask:0xf bank_mask:0xf
    v_cndmask_b32_dpp v119, v163, v167, vcc quad_perm:[1,0,3,2] row_mask:0xf bank_mask:0xf
    v_cndmask_b32_dpp v124, v168, v172, vcc quad_perm:[1,0,3,2] row_mask:0xf bank_mask:0xf
    v_cndmask_b32_dpp v125, v169, v173, vcc quad_perm:[1,0,3,2] row_mask:0xf bank_mask:0xf
    v_cndmask_b32_dpp v126, v170, v174, vcc quad_perm:[1,0,3,2] row_mask:0xf bank_mask:0xf
    v_cndmask_b32_dpp v127, v171, v175, vcc quad_perm:[1,0,3,2] row_mask:0xf bank_mask:0xf
    s_mov_b64 vcc, s[30:31]
    v_cndmask_b32_dpp v160, v120, v112, vcc quad_perm:[2,3,0,1] row_mask:0xf bank_mask:0xf
    v_cndmask_b32_dpp v161, v121, v113, vcc quad_perm:[2,3,0,1] row_mask:0xf bank_mask:0xf
    v_cndmask_b32_dpp v162, v122, v114, vcc quad_perm:[2,3,0,1] row_mask:0xf bank_mask:0xf
    v_cndmask_b32_dpp v163, v123, v115, vcc quad_perm:[2,3,0,1] row_mask:0xf bank_mask:0xf
    v_cndmask_b32_dpp v164, v124, v116, vcc quad_perm:[2,3,0,1] row_mask:0xf bank_mask:0xf
    v_cndmask_b32_dpp v165, v125, v117, vcc quad_perm:[2,3,0,1] row_mask:0xf bank_mask:0xf
    v_cndmask_b32_dpp v166, v126, v118, vcc quad_perm:[2,3,0,1] row_mask:0xf bank_mask:0xf
    v_cndmask_b32_dpp v167, v127, v119, vcc quad_perm:[2,3,0,1] row_mask:0xf bank_mask:0xf
    s_mov_b64 vcc, s[32:33]
    v_cndmask_b32_dpp v168, v112, v120, vcc quad_perm:[2,3,0,1] row_mask:0xf bank_mask:0xf
    v_cndmask_b32_dpp v169, v113, v121, vcc quad_perm:[2,3,0,1] row_mask:0xf bank_mask:0xf
    v_cndmask_b32_dpp v170, v114, v122, vcc quad_perm:[2,3,0,1] row_mask:0xf bank_mask:0xf
    v_cndmask_b32_dpp v171, v115, v123, vcc quad_perm:[2,3,0,1] row_mask:0xf bank_mask:0xf
    v_cndmask_b32_dpp v172, v116, v124, vcc quad_perm:[2,3,0,1] row_mask:0xf bank_mask:0xf
    v_cndmask_b32_dpp v173, v117, v125, vcc quad_perm:[2,3,0,1] row_mask:0xf bank_mask:0xf
    v_cndmask_b32_dpp v174, v118, v126, vcc quad_perm:[2,3,0,1] row_mask:0xf bank_mask:0xf
    v_cndmask_b32_dpp v175, v119, v127, vcc quad_perm:[2,3,0,1] row_mask:0xf bank_mask:0xf
    ds_read_b128 v[4:7], v1 offset:0
    s_waitcnt lgkmcnt(0)
    v_or3_b32 v9, v4, v5, v6
    v_or_b32 v9, v9, v7
    s_nop 0
    v_readfirstlane_b32 s69, v9
    s_nop 0
    s_cmp_eq_u32 s69, 0
    s_cbranch_scc0 Lslow_1
Lret_2:
    ds_read_b64_tr_b16 v[80:81], v128 offset:0
    ds_read_b64_tr_b16 v[82:83], v128 offset:1024
    ds_read_b64_tr_b16 v[84:85], v129 offset:0
    ds_read_b64_tr_b16 v[86:87], v129 offset:1024
    ds_read_b64_tr_b16 v[88:89], v130 offset:0
    ds_read_b64_tr_b16 v[90:91], v130 offset:1024
    ds_read_b64_tr_b16 v[92:93], v131 offset:0
    ds_read_b64_tr_b16 v[94:95], v131 offset:1024
    ds_read_b64_tr_b16 v[96:97], v128 offset:2048
    ds_read_b64_tr_b16 v[98:99], v128 offset:3072
    ds_read_b64_tr_b16 v[100:101], v129 offset:2048
    ds_read_b64_tr_b16 v[102:103], v129 offset:3072
    ds_read_b64_tr_b16 v[104:105], v130 offset:2048
    ds_read_b64_tr_b16 v[106:107], v130 offset:3072
    s_waitcnt lgkmcnt(10)
    v_mfma_f32_32x32x16_bf16 v[16:31], v[80:83], v[160:163], 0
    ds_read_b64_tr_b16 v[108:109], v131 offset:2048
    ds_read_b64_tr_b16 v[110:111], v131 offset:3072
    v_mfma_f32_32x32x16_bf16 v[32:47], v[84:87], v[160:163], 0
    ds_read_b64_tr_b16 v[80:81], v128 offset:4096
    ds_read_b64_tr_b16 v[82:83], v128 offset:5120
    buffer_load_dwordx4 v[192:195], v8, s[48:51], s20 offen offset:0
    s_waitcnt lgkmcnt(10)
    v_mfma_f32_32x32x16_bf16 v[48:63], v[88:91], v[160:163], 0
    ds_read_b64_tr_b16 v[84:85], v129 offset:4096
    ds_read_b64_tr_b16 v[86:87], v129 offset:5120
    v_mfma_f32_32x32x16_bf16 v[64:79], v[92:95], v[160:163], 0
    ds_read_b64_tr_b16 v[88:89], v130 offset:4096
    ds_read_b64_tr_b16 v[90:91], v130 offset:5120
    s_waitcnt vmcnt(5)
    v_mov_b32 v9, 0
    ds_write_b32 v2, v9 offset:64
    buffer_load_dwordx4 v[196:199], v8, s[48:51], s20 offen offset:1024
    s_waitcnt vmcnt(2)
    s_mov_b64 vcc, s[26:27]
    v_cndmask_b32_dpp v112, v180, v176, vcc quad_perm:[1,0,3,2] row_mask:0xf bank_mask:0xf
    v_cndmask_b32_dpp v113, v181, v177, vcc quad_perm:[1,0,3,2] row_mask:0xf bank_mask:0xf
    s_waitcnt lgkmcnt(11)
    v_mfma_f32_32x32x16_bf16 v[16:31], v[96:99], v[164:167], v[16:31]
    ds_read_b64_tr_b16 v[92:93], v131 offset:4096
    ds_read_b64_tr_b16 v[94:95], v131 offset:5120
    v_cndmask_b32_dpp v114, v182, v178, vcc quad_perm:[1,0,3,2] row_mask:0xf bank_mask:0xf
    v_cndmask_b32_dpp v115, v183, v179, vcc quad_perm:[1,0,3,2] row_mask:0xf bank_mask:0xf
    v_cndmask_b32_dpp v120, v188, v184, vcc quad_perm:[1,0,3,2] row_mask:0xf bank_mask:0xf
    v_mfma_f32_32x32x16_bf16 v[32:47], v[100:103], v[164:167], v[32:47]
    ds_read_b64_tr_b16 v[96:97], v128 offset:6144
    ds_read_b64_tr_b16 v[98:99], v128 offset:7168
    buffer_load_dwordx4 v[200:203], v8, s[48:51], s20 offen offset:2048
    v_cndmask_b32_dpp v121, v189, v185, vcc quad_perm:[1,0,3,2] row_mask:0xf bank_mask:0xf
    v_cndmask_b32_dpp v122, v190, v186, vcc quad_perm:[1,0,3,2] row_mask:0xf bank_mask:0xf
    v_cndmask_b32_dpp v123, v191, v187, vcc quad_perm:[1,0,3,2] row_mask:0xf bank_mask:0xf
    s_waitcnt lgkmcnt(11)
    v_mfma_f32_32x32x16_bf16 v[48:63], v[104:107], v[164:167], v[48:63]
    ds_read_b64_tr_b16 v[100:101], v129 offset:6144
    ds_read_b64_tr_b16 v[102:103], v129 offset:7168
    ds_read_b128 v[4:7], v1 offset:16
    s_mov_b64 vcc, s[28:29]
    v_cndmask_b32_dpp v116, v176, v180, vcc quad_perm:[1,0,3,2] row_mask:0xf bank_mask:0xf
    v_cndmask_b32_dpp v117, v177, v181, vcc quad_perm:[1,0,3,2] row_mask:0xf bank_mask:0xf
    v_mfma_f32_32x32x16_bf16 v[64:79], v[108:111], v[164:167], v[64:79]
    ds_read_b64_tr_b16 v[104:105], v130 offset:6144
    ds_read_b64_tr_b16 v[106:107], v130 offset:7168
    buffer_load_dwordx4 v[204:207], v8, s[48:51], s20 offen offset:3072
    v_cndmask_b32_dpp v118, v178, v182, vcc quad_perm:[1,0,3,2] row_mask:0xf bank_mask:0xf
    v_cndmask_b32_dpp v119, v179, v183, vcc quad_perm:[1,0,3,2] row_mask:0xf bank_mask:0xf
    v_cndmask_b32_dpp v124, v184, v188, vcc quad_perm:[1,0,3,2] row_mask:0xf bank_mask:0xf
    s_waitcnt lgkmcnt(12)
    v_mfma_f32_32x32x16_bf16 v[16:31], v[80:83], v[168:171], v[16:31]
    ds_read_b64_tr_b16 v[108:109], v131 offset:6144
    ds_read_b64_tr_b16 v[110:111], v131 offset:7168
    v_cndmask_b32_dpp v125, v185, v189, vcc quad_perm:[1,0,3,2] row_mask:0xf bank_mask:0xf
    v_cndmask_b32_dpp v126, v186, v190, vcc quad_perm:[1,0,3,2] row_mask:0xf bank_mask:0xf
    v_cndmask_b32_dpp v127, v187, v191, vcc quad_perm:[1,0,3,2] row_mask:0xf bank_mask:0xf
    v_mfma_f32_32x32x16_bf16 v[32:47], v[84:87], v[168:171], v[32:47]
    s_waitcnt lgkmcnt(4)
    v_or3_b32 v9, v4, v5, v6
    v_or_b32 v9, v9, v7
    s_nop 0
    v_readfirstlane_b32 s69, v9
    s_nop 0
    s_cmp_eq_u32 s69, 0
    s_cbranch_scc0 Lslow_4
Lret_5:
    ds_read_b64_tr_b16 v[80:81], v128 offset:16384
    ds_read_b64_tr_b16 v[82:83], v128 offset:17408
    buffer_load_dwordx4 v[208:211], v8, s[48:51], s21 offen offset:0
    s_mov_b64 vcc, s[30:31]
    v_cndmask_b32_dpp v176, v120, v112, vcc quad_perm:[2,3,0,1] row_mask:0xf bank_mask:0xf
    v_cndmask_b32_dpp v177, v121, v113, vcc quad_perm:[2,3,0,1] row_mask:0xf bank_mask:0xf
    v_mfma_f32_32x32x16_bf16 v[48:63], v[88:91], v[168:171], v[48:63]
    ds_read_b64_tr_b16 v[84:85], v129 offset:16384
    ds_read_b64_tr_b16 v[86:87], v129 offset:17408
    v_cndmask_b32_dpp v178, v122, v114, vcc quad_perm:[2,3,0,1] row_mask:0xf bank_mask:0xf
    v_cndmask_b32_dpp v179, v123, v115, vcc quad_perm:[2,3,0,1] row_mask:0xf bank_mask:0xf
    v_cndmask_b32_dpp v180, v124, v116, vcc quad_perm:[2,3,0,1] row_mask:0xf bank_mask:0xf
    v_mfma_f32_32x32x16_bf16 v[64:79], v[92:95], v[168:171], v[64:79]
    ds_read_b64_tr_b16 v[88:89], v130 offset:16384
    ds_read_b64_tr_b16 v[90:91], v130 offset:17408
    buffer_load_dwordx4 v[212:215], v8, s[48:51], s21 offen offset:1024
    v_cndmask_b32_dpp v181, v125, v117, vcc quad_perm:[2,3,0,1] row_mask:0xf bank_mask:0xf
    v_cndmask_b32_dpp v182, v126, v118, vcc quad_perm:[2,3,0,1] row_mask:0xf bank_mask:0xf
    v_cndmask_b32_dpp v183, v127, v119, vcc quad_perm:[2,3,0,1] row_mask:0xf bank_mask:0xf
    v_mfma_f32_32x32x16_bf16 v[16:31], v[96:99], v[172:175], v[16:31]
    ds_read_b64_tr_b16 v[92:93], v131 offset:16384
    ds_read_b64_tr_b16 v[94:95], v131 offset:17408
    s_mov_b64 vcc, s[32:33]
    v_cndmask_b32_dpp v184, v112, v120, vcc quad_perm:[2,3,0,1] row_mask:0xf bank_mask:0xf
    v_cndmask_b32_dpp v185, v113, v121, vcc quad_perm:[2,3,0,1] row_mask:0xf bank_mask:0xf
    v_mfma_f32_32x32x16_bf16 v[32:47], v[100:103], v[172:175], v[32:47]
    ds_read_b64_tr_b16 v[96:97], v128 offset:18432
    ds_read_b64_tr_b16 v[98:99], v128 offset:19456
    buffer_load_dwordx4 v[216:219], v8, s[48:51], s21 offen offset:2048
    v_cndmask_b32_dpp v186, v114, v122, vcc quad_perm:[2,3,0,1] row_mask:0xf bank_mask:0xf
    v_cndmask_b32_dpp v187, v115, v123, vcc quad_perm:[2,3,0,1] row_mask:0xf bank_mask:0xf
    v_cndmask_b32_dpp v188, v116, v124, vcc quad_perm:[2,3,0,1] row_mask:0xf bank_mask:0xf
    s_waitcnt lgkmcnt(10)
    v_mfma_f32_32x32x16_bf16 v[48:63], v[104:107], v[172:175], v[48:63]
    ds_read_b64_tr_b16 v[100:101], v129 offset:18432
    ds_read_b64_tr_b16 v[102:103], v129 offset:19456
    v_cndmask_b32_dpp v189, v117, v125, vcc quad_perm:[2,3,0,1] row_mask:0xf bank_mask:0xf
    v_cndmask_b32_dpp v190, v118, v126, vcc quad_perm:[2,3,0,1] row_mask:0xf bank_mask:0xf
    v_cndmask_b32_dpp v191, v119, v127, vcc quad_perm:[2,3,0,1] row_mask:0xf bank_mask:0xf
    v_mfma_f32_32x32x16_bf16 v[64:79], v[108:111], v[172:175], v[64:79]
    ds_read_b64_tr_b16 v[104:105], v130 offset:18432
    ds_read_b64_tr_b16 v[106:107], v130 offset:19456
    buffer_load_dwordx4 v[220:223], v8, s[48:51], s21 offen offset:3072
    s_waitcnt lgkmcnt(10)
    v_mfma_f32_32x32x16_bf16 v[16:31], v[80:83], v[176:179], v[16:31]
    ds_read_b64_tr_b16 v[108:109], v131 offset:18432
    ds_read_b64_tr_b16 v[110:111], v131 offset:19456
    v_mfma_f32_32x32x16_bf16 v[32:47], v[84:87], v[176:179], v[32:47]
    ds_read_b64_tr_b16 v[80:81], v128 offset:20480
    ds_read_b64_tr_b16 v[82:83], v128 offset:21504
    buffer_load_dwordx4 v[160:163], v8, s[48:51], s22 offen offset:0
    s_waitcnt lgkmcnt(10)
    v_mfma_f32_32x32x16_bf16 v[48:63], v[88:91], v[176:179], v[48:63]
    ds_read_b64_tr_b16 v[84:85], v129 offset:20480
    ds_read_b64_tr_b16 v[86:87], v129 offset:21504
    v_mfma_f32_32x32x16_bf16 v[64:79], v[92:95], v[176:179], v[64:79]
    ds_read_b64_tr_b16 v[88:89], v130 offset:20480
    ds_read_b64_tr_b16 v[90:91], v130 offset:21504
    s_waitcnt vmcnt(5)
    s_mov_b64 vcc, s[26:27]
    v_cndmask_b32_dpp v112, v196, v192, vcc quad_perm:[1,0,3,2] row_mask:0xf bank_mask:0xf
    v_cndmask_b32_dpp v113, v197, v193, vcc quad_perm:[1,0,3,2] row_mask:0xf bank_mask:0xf
    s_waitcnt lgkmcnt(10)
    v_mfma_f32_32x32x16_bf16 v[16:31], v[96:99], v[180:183], v[16:31]
    ds_read_b64_tr_b16 v[92:93], v131 offset:20480
    ds_read_b64_tr_b16 v[94:95], v131 offset:21504
    v_cndmask_b32_dpp v114, v198, v194, vcc quad_perm:[1,0,3,2] row_mask:0xf bank_mask:0xf
    v_cndmask_b32_dpp v115, v199, v195, vcc quad_perm:[1,0,3,2] row_mask:0xf bank_mask:0xf
    v_cndmask_b32_dpp v120, v204, v200, vcc quad_perm:[1,0,3,2] row_mask:0xf bank_mask:0xf
    v_mfma_f32_32x32x16_bf16 v[32:47], v[100:103], v[180:183], v[32:47]
    ds_read_b64_tr_b16 v[96:97], v128 offset:22528
    ds_read_b64_tr_b16 v[98:99], v128 offset:23552
    buffer_load_dwordx4 v[164:167], v8, s[48:51], s22 offen offset:1024
    v_cndmask_b32_dpp v121, v205, v201, vcc quad_perm:[1,0,3,2] row_mask:0xf bank_mask:0xf
    v_cndmask_b32_dpp v122, v206, v202, vcc quad_perm:[1,0,3,2] row_mask:0xf bank_mask:0xf
    v_cndmask_b32_dpp v123, v207, v203, vcc quad_perm:[1,0,3,2] row_mask:0xf bank_mask:0xf
    s_waitcnt lgkmcnt(10)
    v_mfma_f32_32x32x16_bf16 v[48:63], v[104:107], v[180:183], v[48:63]
    ds_read_b64_tr_b16 v[100:101], v129 offset:22528
    ds_read_b64_tr_b16 v[102:103], v129 offset:23552
    ds_read_b128 v[4:7], v1 offset:32
    s_mov_b64 vcc, s[28:29]
    v_cndmask_b32_dpp v116, v192, v196, vcc quad_perm:[1,0,3,2] row_mask:0xf bank_mask:0xf
    v_cndmask_b32_dpp v117, v193, v197, vcc quad_perm:[1,0,3,2] row_mask:0xf bank_mask:0xf
    v_mfma_f32_32x32x16_bf16 v[64:79], v[108:111], v[180:183], v[64:79]
    ds_read_b64_tr_b16 v[104:105], v130 offset:22528
    ds_read_b64_tr_b16 v[106:107], v130 offset:23552
    v_cndmask_b32_dpp v118, v194, v198, vcc quad_perm:[1,0,3,2] row_mask:0xf bank_mask:0xf
    v_cndmask_b32_dpp v119, v195, v199, vcc quad_perm:[1,0,3,2] row_mask:0xf bank_mask:0xf
    v_cndmask_b32_dpp v124, v200, v204, vcc quad_perm:[1,0,3,2] row_mask:0xf bank_mask:0xf
    s_waitcnt lgkmcnt(11)
    v_mfma_f32_32x32x16_bf16 v[16:31], v[80:83], v[184:187], v[16:31]
    ds_read_b64_tr_b16 v[108:109], v131 offset:22528
    ds_read_b64_tr_b16 v[110:111], v131 offset:23552
    v_cndmask_b32_dpp v125, v201, v205, vcc quad_perm:[1,0,3,2] row_mask:0xf bank_mask:0xf
    v_cndmask_b32_dpp v126, v202, v206, vcc quad_perm:[1,0,3,2] row_mask:0xf bank_mask:0xf
    v_cndmask_b32_dpp v127, v203, v207, vcc quad_perm:[1,0,3,2] row_mask:0xf bank_mask:0xf
    v_mfma_f32_32x32x16_bf16 v[32:47], v[84:87], v[184:187], v[32:47]
    s_waitcnt lgkmcnt(4)
    v_or3_b32 v9, v4, v5, v6
    v_or_b32 v9, v9, v7
    s_nop 0
    v_readfirstlane_b32 s69, v9
    s_nop 0
    s_cmp_eq_u32 s69, 0
    s_cbranch_scc0 Lslow_7
Lret_8:
    ds_read_b64_tr_b16 v[80:81], v128 offset:32768
    ds_read_b64_tr_b16 v[82:83], v128 offset:33792
    buffer_load_dwordx4 v[168:171], v8, s[48:51], s22 offen offset:2048
    s_mov_b64 vcc, s[30:31]
    v_cndmask_b32_dpp v192, v120, v112, vcc quad_perm:[2,3,0,1] row_mask:0xf bank_mask:0xf
    v_cndmask_b32_dpp v193, v121, v113, vcc quad_perm:[2,3,0,1] row_mask:0xf bank_mask:0xf
    v_mfma_f32_32x32x16_bf16 v[48:63], v[88:91], v[184:187], v[48:63]
    ds_read_b64_tr_b16 v[84:85], v129 offset:32768
    ds_read_b64_tr_b16 v[86:87], v129 offset:33792
    v_cndmask_b32_dpp v194, v122, v114, vcc quad_perm:[2,3,0,1] row_mask:0xf bank_mask:0xf
    v_cndmask_b32_dpp v195, v123, v115, vcc quad_perm:[2,3,0,1] row_mask:0xf bank_mask:0xf
    v_cndmask_b32_dpp v196, v124, v116, vcc quad_perm:[2,3,0,1] row_mask:0xf bank_mask:0xf
    v_mfma_f32_32x32x16_bf16 v[64:79], v[92:95], v[184:187], v[64:79]
    ds_read_b64_tr_b16 v[88:89], v130 offset:32768
    ds_read_b64_tr_b16 v[90:91], v130 offset:33792
    v_cndmask_b32_dpp v197, v125, v117, vcc quad_perm:[2,3,0,1] row_mask:0xf bank_mask:0xf
    v_cndmask_b32_dpp v198, v126, v118, vcc quad_perm:[2,3,0,1] row_mask:0xf bank_mask:0xf
    v_cndmask_b32_dpp v199, v127, v119, vcc quad_perm:[2,3,0,1] row_mask:0xf bank_mask:0xf
    v_mfma_f32_32x32x16_bf16 v[16:31], v[96:99], v[188:191], v[16:31]
    ds_read_b64_tr_b16 v[92:93], v131 offset:32768
    ds_read_b64_tr_b16 v[94:95], v131 offset:33792
    s_mov_b64 vcc, s[32:33]
    v_cndmask_b32_dpp v200, v112, v120, vcc quad_perm:[2,3,0,1] row_mask:0xf bank_mask:0xf
    v_cndmask_b32_dpp v201, v113, v121, vcc quad_perm:[2,3,0,1] row_mask:0xf bank_mask:0xf
    v_mfma_f32_32x32x16_bf16 v[32:47], v[100:103], v[188:191], v[32:47]
    ds_read_b64_tr_b16 v[96:97], v128 offset:34816
    ds_read_b64_tr_b16 v[98:99], v128 offset:35840
    buffer_load_dwordx4 v[172:175], v8, s[48:51], s22 offen offset:3072
    v_cndmask_b32_dpp v202, v114, v122, vcc quad_perm:[2,3,0,1] row_mask:0xf bank_mask:0xf
    v_cndmask_b32_dpp v203, v115, v123, vcc quad_perm:[2,3,0,1] row_mask:0xf bank_mask:0xf
    v_cndmask_b32_dpp v204, v116, v124, vcc quad_perm:[2,3,0,1] row_mask:0xf bank_mask:0xf
    s_waitcnt lgkmcnt(10)
    v_mfma_f32_32x32x16_bf16 v[48:63], v[104:107], v[188:191], v[48:63]
    ds_read_b64_tr_b16 v[100:101], v129 offset:34816
    ds_read_b64_tr_b16 v[102:103], v129 offset:35840
    v_cndmask_b32_dpp v205, v117, v125, vcc quad_perm:[2,3,0,1] row_mask:0xf bank_mask:0xf
    v_cndmask_b32_dpp v206, v118, v126, vcc quad_perm:[2,3,0,1] row_mask:0xf bank_mask:0xf
    v_cndmask_b32_dpp v207, v119, v127, vcc quad_perm:[2,3,0,1] row_mask:0xf bank_mask:0xf
    v_mfma_f32_32x32x16_bf16 v[64:79], v[108:111], v[188:191], v[64:79]
    ds_read_b64_tr_b16 v[104:105], v130 offset:34816
    ds_read_b64_tr_b16 v[106:107], v130 offset:35840
    s_add_u32 m0, s75, 0
    s_mov_b64 exec, 1
    buffer_load_dword off, s[52:55], 0 lds
    s_mov_b64 exec, -1
    s_waitcnt lgkmcnt(10)
    v_mfma_f32_32x32x16_bf16 v[16:31], v[80:83], v[192:195], v[16:31]
    ds_read_b64_tr_b16 v[108:109], v131 offset:34816
    ds_read_b64_tr_b16 v[110:111], v131 offset:35840
    v_mfma_f32_32x32x16_bf16 v[32:47], v[84:87], v[192:195], v[32:47]
    ds_read_b64_tr_b16 v[80:81], v128 offset:36864
    ds_read_b64_tr_b16 v[82:83], v128 offset:37888
    buffer_load_dwordx4 v[176:179], v8, s[48:51], s23 offen offset:0
    s_waitcnt lgkmcnt(10)
    v_mfma_f32_32x32x16_bf16 v[48:63], v[88:91], v[192:195], v[48:63]
    ds_read_b64_tr_b16 v[84:85], v129 offset:36864
    ds_read_b64_tr_b16 v[86:87], v129 offset:37888
    v_mfma_f32_32x32x16_bf16 v[64:79], v[92:95], v[192:195], v[64:79]
    ds_read_b64_tr_b16 v[88:89], v130 offset:36864
    ds_read_b64_tr_b16 v[90:91], v130 offset:37888
    s_waitcnt vmcnt(6)
    s_mov_b64 vcc, s[26:27]
    v_cndmask_b32_dpp v112, v212, v208, vcc quad_perm:[1,0,3,2] row_mask:0xf bank_mask:0xf
    v_cndmask_b32_dpp v113, v213, v209, vcc quad_perm:[1,0,3,2] row_mask:0xf bank_mask:0xf
    s_waitcnt lgkmcnt(10)
    v_mfma_f32_32x32x16_bf16 v[16:31], v[96:99], v[196:199], v[16:31]
    ds_read_b64_tr_b16 v[92:93], v131 offset:36864
    ds_read_b64_tr_b16 v[94:95], v131 offset:37888
    v_cndmask_b32_dpp v114, v214, v210, vcc quad_perm:[1,0,3,2] row_mask:0xf bank_mask:0xf
    v_cndmask_b32_dpp v115, v215, v211, vcc quad_perm:[1,0,3,2] row_mask:0xf bank_mask:0xf
    v_cndmask_b32_dpp v120, v220, v216, vcc quad_perm:[1,0,3,2] row_mask:0xf bank_mask:0xf
    v_mfma_f32_32x32x16_bf16 v[32:47], v[100:103], v[196:199], v[32:47]
    ds_read_b64_tr_b16 v[96:97], v128 offset:38912
    ds_read_b64_tr_b16 v[98:99], v128 offset:39936
    buffer_load_dwordx4 v[180:183], v8, s[48:51], s23 offen offset:1024
    v_cndmask_b32_dpp v121, v221, v217, vcc quad_perm:[1,0,3,2] row_mask:0xf bank_mask:0xf
    v_cndmask_b32_dpp v122, v222, v218, vcc quad_perm:[1,0,3,2] row_mask:0xf bank_mask:0xf
    v_cndmask_b32_dpp v123, v223, v219, vcc quad_perm:[1,0,3,2] row_mask:0xf bank_mask:0xf
    s_waitcnt lgkmcnt(10)
    v_mfma_f32_32x32x16_bf16 v[48:63], v[104:107], v[196:199], v[48:63]
    ds_read_b64_tr_b16 v[100:101], v129 offset:38912
    ds_read_b64_tr_b16 v[102:103], v129 offset:39936
    ds_read_b128 v[4:7], v1 offset:48
    s_mov_b64 vcc, s[28:29]
    v_cndmask_b32_dpp v116, v208, v212, vcc quad_perm:[1,0,3,2] row_mask:0xf bank_mask:0xf
    v_cndmask_b32_dpp v117, v209, v213, vcc quad_perm:[1,0,3,2] row_mask:0xf bank_mask:0xf
    v_mfma_f32_32x32x16_bf16 v[64:79], v[108:111], v[196:199], v[64:79]
    ds_read_b64_tr_b16 v[104:105], v130 offset:38912
    ds_read_b64_tr_b16 v[106:107], v130 offset:39936
    v_cndmask_b32_dpp v118, v210, v214, vcc quad_perm:[1,0,3,2] row_mask:0xf bank_mask:0xf
    v_cndmask_b32_dpp v119, v211, v215, vcc quad_perm:[1,0,3,2] row_mask:0xf bank_mask:0xf
    v_cndmask_b32_dpp v124, v216, v220, vcc quad_perm:[1,0,3,2] row_mask:0xf bank_mask:0xf
    s_waitcnt lgkmcnt(11)
    v_mfma_f32_32x32x16_bf16 v[16:31], v[80:83], v[200:203], v[16:31]
    ds_read_b64_tr_b16 v[108:109], v131 offset:38912
    ds_read_b64_tr_b16 v[110:111], v131 offset:39936
    v_cndmask_b32_dpp v125, v217, v221, vcc quad_perm:[1,0,3,2] row_mask:0xf bank_mask:0xf
    v_cndmask_b32_dpp v126, v218, v222, vcc quad_perm:[1,0,3,2] row_mask:0xf bank_mask:0xf
    v_cndmask_b32_dpp v127, v219, v223, vcc quad_perm:[1,0,3,2] row_mask:0xf bank_mask:0xf
    v_mfma_f32_32x32x16_bf16 v[32:47], v[84:87], v[200:203], v[32:47]
    s_waitcnt lgkmcnt(4)
    v_or3_b32 v9, v4, v5, v6
    v_or_b32 v9, v9, v7
    s_nop 0
    v_readfirstlane_b32 s69, v9
    s_nop 0
    s_cmp_eq_u32 s69, 0
    s_cbranch_scc0 Lslow_10
Lret_11:
    ds_read_b64_tr_b16 v[80:81], v128 offset:49152
    ds_read_b64_tr_b16 v[82:83], v128 offset:50176
    buffer_load_dwordx4 v[184:187], v8, s[48:51], s23 offen offset:2048
    s_mov_b64 vcc, s[30:31]
    v_cndmask_b32_dpp v208, v120, v112, vcc quad_perm:[2,3,0,1] row_mask:0xf bank_mask:0xf
    v_cndmask_b32_dpp v209, v121, v113, vcc quad_perm:[2,3,0,1] row_mask:0xf bank_mask:0xf
    v_mfma_f32_32x32x16_bf16 v[48:63], v[88:91], v[200:203], v[48:63]
    ds_read_b64_tr_b16 v[84:85], v129 offset:49152
    ds_read_b64_tr_b16 v[86:87], v129 offset:50176
    v_cndmask_b32_dpp v210, v122, v114, vcc quad_perm:[2,3,0,1] row_mask:0xf bank_mask:0xf
    v_cndmask_b32_dpp v211, v123, v115, vcc quad_perm:[2,3,0,1] row_mask:0xf bank_mask:0xf
    v_cndmask_b32_dpp v212, v124, v116, vcc quad_perm:[2,3,0,1] row_mask:0xf bank_mask:0xf
    v_mfma_f32_32x32x16_bf16 v[64:79], v[92:95], v[200:203], v[64:79]
    ds_read_b64_tr_b16 v[88:89], v130 offset:49152
    ds_read_b64_tr_b16 v[90:91], v130 offset:50176
    v_cndmask_b32_dpp v213, v125, v117, vcc quad_perm:[2,3,0,1] row_mask:0xf bank_mask:0xf
    v_cndmask_b32_dpp v214, v126, v118, vcc quad_perm:[2,3,0,1] row_mask:0xf bank_mask:0xf
    v_cndmask_b32_dpp v215, v127, v119, vcc quad_perm:[2,3,0,1] row_mask:0xf bank_mask:0xf
    v_mfma_f32_32x32x16_bf16 v[16:31], v[96:99], v[204:207], v[16:31]
    ds_read_b64_tr_b16 v[92:93], v131 offset:49152
    ds_read_b64_tr_b16 v[94:95], v131 offset:50176
    s_mov_b64 vcc, s[32:33]
    v_cndmask_b32_dpp v216, v112, v120, vcc quad_perm:[2,3,0,1] row_mask:0xf bank_mask:0xf
    v_cndmask_b32_dpp v217, v113, v121, vcc quad_perm:[2,3,0,1] row_mask:0xf bank_mask:0xf
    v_mfma_f32_32x32x16_bf16 v[32:47], v[100:103], v[204:207], v[32:47]
    ds_read_b64_tr_b16 v[96:97], v128 offset:51200
    ds_read_b64_tr_b16 v[98:99], v128 offset:52224
    buffer_load_dwordx4 v[188:191], v8, s[48:51], s23 offen offset:3072
    v_cndmask_b32_dpp v218, v114, v122, vcc quad_perm:[2,3,0,1] row_mask:0xf bank_mask:0xf
    v_cndmask_b32_dpp v219, v115, v123, vcc quad_perm:[2,3,0,1] row_mask:0xf bank_mask:0xf
    v_cndmask_b32_dpp v220, v116, v124, vcc quad_perm:[2,3,0,1] row_mask:0xf bank_mask:0xf
    s_waitcnt lgkmcnt(10)
    v_mfma_f32_32x32x16_bf16 v[48:63], v[104:107], v[204:207], v[48:63]
    ds_read_b64_tr_b16 v[100:101], v129 offset:51200
    ds_read_b64_tr_b16 v[102:103], v129 offset:52224
    v_cndmask_b32_dpp v221, v117, v125, vcc quad_perm:[2,3,0,1] row_mask:0xf bank_mask:0xf
    v_cndmask_b32_dpp v222, v118, v126, vcc quad_perm:[2,3,0,1] row_mask:0xf bank_mask:0xf
    v_cndmask_b32_dpp v223, v119, v127, vcc quad_perm:[2,3,0,1] row_mask:0xf bank_mask:0xf
    v_mfma_f32_32x32x16_bf16 v[64:79], v[108:111], v[204:207], v[64:79]
    ds_read_b64_tr_b16 v[104:105], v130 offset:51200
    ds_read_b64_tr_b16 v[106:107], v130 offset:52224
    s_waitcnt lgkmcnt(10)
    v_mfma_f32_32x32x16_bf16 v[16:31], v[80:83], v[208:211], v[16:31]
    ds_read_b64_tr_b16 v[108:109], v131 offset:51200
    ds_read_b64_tr_b16 v[110:111], v131 offset:52224
    v_mfma_f32_32x32x16_bf16 v[32:47], v[84:87], v[208:211], v[32:47]
    ds_read_b64_tr_b16 v[80:81], v128 offset:53248
    ds_read_b64_tr_b16 v[82:83], v128 offset:54272
    buffer_load_dwordx4 v[192:195], v8, s[48:51], s24 offen offset:0
    s_waitcnt lgkmcnt(10)
    v_mfma_f32_32x32x16_bf16 v[48:63], v[88:91], v[208:211], v[48:63]
    ds_read_b64_tr_b16 v[84:85], v129 offset:53248
    ds_read_b64_tr_b16 v[86:87], v129 offset:54272
    v_mfma_f32_32x32x16_bf16 v[64:79], v[92:95], v[208:211], v[64:79]
    ds_read_b64_tr_b16 v[88:89], v130 offset:53248
    ds_read_b64_tr_b16 v[90:91], v130 offset:54272
    s_waitcnt vmcnt(6)
    s_mov_b64 vcc, s[26:27]
    v_cndmask_b32_dpp v112, v164, v160, vcc quad_perm:[1,0,3,2] row_mask:0xf bank_mask:0xf
    v_cndmask_b32_dpp v113, v165, v161, vcc quad_perm:[1,0,3,2] row_mask:0xf bank_mask:0xf
    s_waitcnt lgkmcnt(10)
    v_mfma_f32_32x32x16_bf16 v[16:31], v[96:99], v[212:215], v[16:31]
    ds_read_b64_tr_b16 v[92:93], v131 offset:53248
    ds_read_b64_tr_b16 v[94:95], v131 offset:54272
    v_cndmask_b32_dpp v114, v166, v162, vcc quad_perm:[1,0,3,2] row_mask:0xf bank_mask:0xf
    v_cndmask_b32_dpp v115, v167, v163, vcc quad_perm:[1,0,3,2] row_mask:0xf bank_mask:0xf
    v_cndmask_b32_dpp v120, v172, v168, vcc quad_perm:[1,0,3,2] row_mask:0xf bank_mask:0xf
    v_mfma_f32_32x32x16_bf16 v[32:47], v[100:103], v[212:215], v[32:47]
    ds_read_b64_tr_b16 v[96:97], v128 offset:55296
    ds_read_b64_tr_b16 v[98:99], v128 offset:56320
    buffer_load_dwordx4 v[196:199], v8, s[48:51], s24 offen offset:1024
    v_cndmask_b32_dpp v121, v173, v169, vcc quad_perm:[1,0,3,2] row_mask:0xf bank_mask:0xf
    v_cndmask_b32_dpp v122, v174, v170, vcc quad_perm:[1,0,3,2] row_mask:0xf bank_mask:0xf
    v_cndmask_b32_dpp v123, v175, v171, vcc quad_perm:[1,0,3,2] row_mask:0xf bank_mask:0xf
    s_waitcnt lgkmcnt(10)
    v_mfma_f32_32x32x16_bf16 v[48:63], v[104:107], v[212:215], v[48:63]
    ds_read_b64_tr_b16 v[100:101], v129 offset:55296
    ds_read_b64_tr_b16 v[102:103], v129 offset:56320
    ds_read_b128 v[4:7], v1 offset:64
    s_mov_b64 vcc, s[28:29]
    v_cndmask_b32_dpp v116, v160, v164, vcc quad_perm:[1,0,3,2] row_mask:0xf bank_mask:0xf
    v_cndmask_b32_dpp v117, v161, v165, vcc quad_perm:[1,0,3,2] row_mask:0xf bank_mask:0xf
    v_mfma_f32_32x32x16_bf16 v[64:79], v[108:111], v[212:215], v[64:79]
    ds_read_b64_tr_b16 v[104:105], v130 offset:55296
    ds_read_b64_tr_b16 v[106:107], v130 offset:56320
    v_cndmask_b32_dpp v118, v162, v166, vcc quad_perm:[1,0,3,2] row_mask:0xf bank_mask:0xf
    v_cndmask_b32_dpp v119, v163, v167, vcc quad_perm:[1,0,3,2] row_mask:0xf bank_mask:0xf
    v_cndmask_b32_dpp v124, v168, v172, vcc quad_perm:[1,0,3,2] row_mask:0xf bank_mask:0xf
    s_waitcnt lgkmcnt(11)
    v_mfma_f32_32x32x16_bf16 v[16:31], v[80:83], v[216:219], v[16:31]
    ds_read_b64_tr_b16 v[108:109], v131 offset:55296
    ds_read_b64_tr_b16 v[110:111], v131 offset:56320
    v_cndmask_b32_dpp v125, v169, v173, vcc quad_perm:[1,0,3,2] row_mask:0xf bank_mask:0xf
    v_cndmask_b32_dpp v126, v170, v174, vcc quad_perm:[1,0,3,2] row_mask:0xf bank_mask:0xf
    v_cndmask_b32_dpp v127, v171, v175, vcc quad_perm:[1,0,3,2] row_mask:0xf bank_mask:0xf
    v_mfma_f32_32x32x16_bf16 v[32:47], v[84:87], v[216:219], v[32:47]
    s_waitcnt lgkmcnt(4)
    v_or3_b32 v9, v4, v5, v6
    v_or_b32 v9, v9, v7
    s_nop 0
    v_readfirstlane_b32 s69, v9
    s_nop 0
    s_cmp_eq_u32 s69, 0
    s_cbranch_scc0 Lslow_13
Lret_14:
    ds_read_b64_tr_b16 v[80:81], v132 offset:0
    ds_read_b64_tr_b16 v[82:83], v132 offset:1024
    buffer_load_dwordx4 v[200:203], v8, s[48:51], s24 offen offset:2048
    s_mov_b64 vcc, s[30:31]
    v_cndmask_b32_dpp v160, v120, v112, vcc quad_perm:[2,3,0,1] row_mask:0xf bank_mask:0xf
    v_cndmask_b32_dpp v161, v121, v113, vcc quad_perm:[2,3,0,1] row_mask:0xf bank_mask:0xf
    v_mfma_f32_32x32x16_bf16 v[48:63], v[88:91], v[216:219], v[48:63]
    ds_read_b64_tr_b16 v[84:85], v133 offset:0
    ds_read_b64_tr_b16 v[86:87], v133 offset:1024
    v_cndmask_b32_dpp v162, v122, v114, vcc quad_perm:[2,3,0,1] row_mask:0xf bank_mask:0xf
    v_cndmask_b32_dpp v163, v123, v115, vcc quad_perm:[2,3,0,1] row_mask:0xf bank_mask:0xf
    v_cndmask_b32_dpp v164, v124, v116, vcc quad_perm:[2,3,0,1] row_mask:0xf bank_mask:0xf
    v_mfma_f32_32x32x16_bf16 v[64:79], v[92:95], v[216:219], v[64:79]
    ds_read_b64_tr_b16 v[88:89], v134 offset:0
    ds_read_b64_tr_b16 v[90:91], v134 offset:1024
    v_cndmask_b32_dpp v165, v125, v117, vcc quad_perm:[2,3,0,1] row_mask:0xf bank_mask:0xf
    v_cndmask_b32_dpp v166, v126, v118, vcc quad_perm:[2,3,0,1] row_mask:0xf bank_mask:0xf
    v_cndmask_b32_dpp v167, v127, v119, vcc quad_perm:[2,3,0,1] row_mask:0xf bank_mask:0xf
    v_mfma_f32_32x32x16_bf16 v[16:31], v[96:99], v[220:223], v[16:31]
    ds_read_b64_tr_b16 v[92:93], v135 offset:0
    ds_read_b64_tr_b16 v[94:95], v135 offset:1024
    s_mov_b64 vcc, s[32:33]
    v_cndmask_b32_dpp v168, v112, v120, vcc quad_perm:[2,3,0,1] row_mask:0xf bank_mask:0xf
    v_cndmask_b32_dpp v169, v113, v121, vcc quad_perm:[2,3,0,1] row_mask:0xf bank_mask:0xf
    v_mfma_f32_32x32x16_bf16 v[32:47], v[100:103], v[220:223], v[32:47]
    ds_read_b64_tr_b16 v[96:97], v132 offset:2048
    ds_read_b64_tr_b16 v[98:99], v132 offset:3072
    buffer_load_dwordx4 v[204:207], v8, s[48:51], s24 offen offset:3072
    v_cndmask_b32_dpp v170, v114, v122, vcc quad_perm:[2,3,0,1] row_mask:0xf bank_mask:0xf
    v_cndmask_b32_dpp v171, v115, v123, vcc quad_perm:[2,3,0,1] row_mask:0xf bank_mask:0xf
    v_cndmask_b32_dpp v172, v116, v124, vcc quad_perm:[2,3,0,1] row_mask:0xf bank_mask:0xf
    s_waitcnt lgkmcnt(10)
    v_mfma_f32_32x32x16_bf16 v[48:63], v[104:107], v[220:223], v[48:63]
    ds_read_b64_tr_b16 v[100:101], v133 offset:2048
    ds_read_b64_tr_b16 v[102:103], v133 offset:3072
    v_cndmask_b32_dpp v173, v117, v125, vcc quad_perm:[2,3,0,1] row_mask:0xf bank_mask:0xf
    v_cndmask_b32_dpp v174, v118, v126, vcc quad_perm:[2,3,0,1] row_mask:0xf bank_mask:0xf
    v_cndmask_b32_dpp v175, v119, v127, vcc quad_perm:[2,3,0,1] row_mask:0xf bank_mask:0xf
    v_mfma_f32_32x32x16_bf16 v[64:79], v[108:111], v[220:223], v[64:79]
    ds_read_b64_tr_b16 v[104:105], v134 offset:2048
    ds_read_b64_tr_b16 v[106:107], v134 offset:3072
    s_add_u32 m0, s75, 16
    s_mov_b64 exec, 1
    buffer_load_dword off, s[52:55], 0 lds
    s_mov_b64 exec, -1
    s_waitcnt lgkmcnt(10)
    v_mfma_f32_32x32x16_bf16 v[16:31], v[80:83], v[160:163], v[16:31]
    ds_read_b64_tr_b16 v[108:109], v135 offset:2048
    ds_read_b64_tr_b16 v[110:111], v135 offset:3072
    v_mfma_f32_32x32x16_bf16 v[32:47], v[84:87], v[160:163], v[32:47]
    ds_read_b64_tr_b16 v[80:81], v132 offset:4096
    ds_read_b64_tr_b16 v[82:83], v132 offset:5120
    buffer_load_dwordx4 v[208:211], v8, s[48:51], s25 offen offset:0
    s_waitcnt lgkmcnt(10)
    v_mfma_f32_32x32x16_bf16 v[48:63], v[88:91], v[160:163], v[48:63]
    ds_read_b64_tr_b16 v[84:85], v133 offset:4096
    ds_read_b64_tr_b16 v[86:87], v133 offset:5120
    v_mfma_f32_32x32x16_bf16 v[64:79], v[92:95], v[160:163], v[64:79]
    ds_read_b64_tr_b16 v[88:89], v134 offset:4096
    ds_read_b64_tr_b16 v[90:91], v134 offset:5120
    s_waitcnt vmcnt(6)
    s_mov_b64 vcc, s[26:27]
    v_cndmask_b32_dpp v112, v180, v176, vcc quad_perm:[1,0,3,2] row_mask:0xf bank_mask:0xf
    v_cndmask_b32_dpp v113, v181, v177, vcc quad_perm:[1,0,3,2] row_mask:0xf bank_mask:0xf
    s_waitcnt lgkmcnt(10)
    v_mfma_f32_32x32x16_bf16 v[16:31], v[96:99], v[164:167], v[16:31]
    ds_read_b64_tr_b16 v[92:93], v135 offset:4096
    ds_read_b64_tr_b16 v[94:95], v135 offset:5120
    v_cndmask_b32_dpp v114, v182, v178, vcc quad_perm:[1,0,3,2] row_mask:0xf bank_mask:0xf
    v_cndmask_b32_dpp v115, v183, v179, vcc quad_perm:[1,0,3,2] row_mask:0xf bank_mask:0xf
    v_cndmask_b32_dpp v120, v188, v184, vcc quad_perm:[1,0,3,2] row_mask:0xf bank_mask:0xf
    v_mfma_f32_32x32x16_bf16 v[32:47], v[100:103], v[164:167], v[32:47]
    ds_read_b64_tr_b16 v[96:97], v132 offset:6144
    ds_read_b64_tr_b16 v[98:99], v132 offset:7168
    buffer_load_dwordx4 v[212:215], v8, s[48:51], s25 offen offset:1024
    v_cndmask_b32_dpp v121, v189, v185, vcc quad_perm:[1,0,3,2] row_mask:0xf bank_mask:0xf
    v_cndmask_b32_dpp v122, v190, v186, vcc quad_perm:[1,0,3,2] row_mask:0xf bank_mask:0xf
    v_cndmask_b32_dpp v123, v191, v187, vcc quad_perm:[1,0,3,2] row_mask:0xf bank_mask:0xf
    s_waitcnt lgkmcnt(10)
    v_mfma_f32_32x32x16_bf16 v[48:63], v[104:107], v[164:167], v[48:63]
    ds_read_b64_tr_b16 v[100:101], v133 offset:6144
    ds_read_b64_tr_b16 v[102:103], v133 offset:7168
    ds_read_b128 v[4:7], v1 offset:80
    s_mov_b64 vcc, s[28:29]
    v_cndmask_b32_dpp v116, v176, v180, vcc quad_perm:[1,0,3,2] row_mask:0xf bank_mask:0xf
    v_cndmask_b32_dpp v117, v177, v181, vcc quad_perm:[1,0,3,2] row_mask:0xf bank_mask:0xf
    v_mfma_f32_32x32x16_bf16 v[64:79], v[108:111], v[164:167], v[64:79]
    ds_read_b64_tr_b16 v[104:105], v134 offset:6144
    ds_read_b64_tr_b16 v[106:107], v134 offset:7168
    v_cndmask_b32_dpp v118, v178, v182, vcc quad_perm:[1,0,3,2] row_mask:0xf bank_mask:0xf
    v_cndmask_b32_dpp v119, v179, v183, vcc quad_perm:[1,0,3,2] row_mask:0xf bank_mask:0xf
    v_cndmask_b32_dpp v124, v184, v188, vcc quad_perm:[1,0,3,2] row_mask:0xf bank_mask:0xf
    s_waitcnt lgkmcnt(11)
    v_mfma_f32_32x32x16_bf16 v[16:31], v[80:83], v[168:171], v[16:31]
    ds_read_b64_tr_b16 v[108:109], v135 offset:6144
    ds_read_b64_tr_b16 v[110:111], v135 offset:7168
    v_cndmask_b32_dpp v125, v185, v189, vcc quad_perm:[1,0,3,2] row_mask:0xf bank_mask:0xf
    v_cndmask_b32_dpp v126, v186, v190, vcc quad_perm:[1,0,3,2] row_mask:0xf bank_mask:0xf
    v_cndmask_b32_dpp v127, v187, v191, vcc quad_perm:[1,0,3,2] row_mask:0xf bank_mask:0xf
    v_mfma_f32_32x32x16_bf16 v[32:47], v[84:87], v[168:171], v[32:47]
    s_waitcnt lgkmcnt(4)
    v_or3_b32 v9, v4, v5, v6
    v_or_b32 v9, v9, v7
    s_nop 0
    v_readfirstlane_b32 s69, v9
    s_nop 0
    s_cmp_eq_u32 s69, 0
    s_cbranch_scc0 Lslow_16
Lret_17:
    ds_read_b64_tr_b16 v[80:81], v132 offset:16384
    ds_read_b64_tr_b16 v[82:83], v132 offset:17408
    buffer_load_dwordx4 v[216:219], v8, s[48:51], s25 offen offset:2048
    s_mov_b64 vcc, s[30:31]
    v_cndmask_b32_dpp v176, v120, v112, vcc quad_perm:[2,3,0,1] row_mask:0xf bank_mask:0xf
    v_cndmask_b32_dpp v177, v121, v113, vcc quad_perm:[2,3,0,1] row_mask:0xf bank_mask:0xf
    v_mfma_f32_32x32x16_bf16 v[48:63], v[88:91], v[168:171], v[48:63]
    ds_read_b64_tr_b16 v[84:85], v133 offset:16384
    ds_read_b64_tr_b16 v[86:87], v133 offset:17408
    v_cndmask_b32_dpp v178, v122, v114, vcc quad_perm:[2,3,0,1] row_mask:0xf bank_mask:0xf
    v_cndmask_b32_dpp v179, v123, v115, vcc quad_perm:[2,3,0,1] row_mask:0xf bank_mask:0xf
    v_cndmask_b32_dpp v180, v124, v116, vcc quad_perm:[2,3,0,1] row_mask:0xf bank_mask:0xf
    v_mfma_f32_32x32x16_bf16 v[64:79], v[92:95], v[168:171], v[64:79]
    ds_read_b64_tr_b16 v[88:89], v134 offset:16384
    ds_read_b64_tr_b16 v[90:91], v134 offset:17408
    v_cndmask_b32_dpp v181, v125, v117, vcc quad_perm:[2,3,0,1] row_mask:0xf bank_mask:0xf
    v_cndmask_b32_dpp v182, v126, v118, vcc quad_perm:[2,3,0,1] row_mask:0xf bank_mask:0xf
    v_cndmask_b32_dpp v183, v127, v119, vcc quad_perm:[2,3,0,1] row_mask:0xf bank_mask:0xf
    v_mfma_f32_32x32x16_bf16 v[16:31], v[96:99], v[172:175], v[16:31]
    ds_read_b64_tr_b16 v[92:93], v135 offset:16384
    ds_read_b64_tr_b16 v[94:95], v135 offset:17408
    s_mov_b64 vcc, s[32:33]
    v_cndmask_b32_dpp v184, v112, v120, vcc quad_perm:[2,3,0,1] row_mask:0xf bank_mask:0xf
    v_cndmask_b32_dpp v185, v113, v121, vcc quad_perm:[2,3,0,1] row_mask:0xf bank_mask:0xf
    v_mfma_f32_32x32x16_bf16 v[32:47], v[100:103], v[172:175], v[32:47]
    ds_read_b64_tr_b16 v[96:97], v132 offset:18432
    ds_read_b64_tr_b16 v[98:99], v132 offset:19456
    buffer_load_dwordx4 v[220:223], v8, s[48:51], s25 offen offset:3072
    v_cndmask_b32_dpp v186, v114, v122, vcc quad_perm:[2,3,0,1] row_mask:0xf bank_mask:0xf
    v_cndmask_b32_dpp v187, v115, v123, vcc quad_perm:[2,3,0,1] row_mask:0xf bank_mask:0xf
    v_cndmask_b32_dpp v188, v116, v124, vcc quad_perm:[2,3,0,1] row_mask:0xf bank_mask:0xf
    s_waitcnt lgkmcnt(10)
    v_mfma_f32_32x32x16_bf16 v[48:63], v[104:107], v[172:175], v[48:63]
    ds_read_b64_tr_b16 v[100:101], v133 offset:18432
    ds_read_b64_tr_b16 v[102:103], v133 offset:19456
    v_cndmask_b32_dpp v189, v117, v125, vcc quad_perm:[2,3,0,1] row_mask:0xf bank_mask:0xf
    v_cndmask_b32_dpp v190, v118, v126, vcc quad_perm:[2,3,0,1] row_mask:0xf bank_mask:0xf
    v_cndmask_b32_dpp v191, v119, v127, vcc quad_perm:[2,3,0,1] row_mask:0xf bank_mask:0xf
    v_mfma_f32_32x32x16_bf16 v[64:79], v[108:111], v[172:175], v[64:79]
    ds_read_b64_tr_b16 v[104:105], v134 offset:18432
    ds_read_b64_tr_b16 v[106:107], v134 offset:19456
    s_mov_b32 s48, s0
    s_mov_b32 s49, s1
    s_mov_b32 s50, 0x1c0000
    s_mov_b32 s51, 0x20000
    s_waitcnt lgkmcnt(10)
    v_mfma_f32_32x32x16_bf16 v[16:31], v[80:83], v[176:179], v[16:31]
    ds_read_b64_tr_b16 v[108:109], v135 offset:18432
    ds_read_b64_tr_b16 v[110:111], v135 offset:19456
    v_mfma_f32_32x32x16_bf16 v[32:47], v[84:87], v[176:179], v[32:47]
    ds_read_b64_tr_b16 v[80:81], v132 offset:20480
    ds_read_b64_tr_b16 v[82:83], v132 offset:21504
    s_waitcnt vmcnt(5)
    s_mov_b64 vcc, s[26:27]
    v_cndmask_b32_dpp v112, v196, v192, vcc quad_perm:[1,0,3,2] row_mask:0xf bank_mask:0xf
    v_cndmask_b32_dpp v113, v197, v193, vcc quad_perm:[1,0,3,2] row_mask:0xf bank_mask:0xf
    v_cndmask_b32_dpp v114, v198, v194, vcc quad_perm:[1,0,3,2] row_mask:0xf bank_mask:0xf
    s_waitcnt lgkmcnt(10)
    v_mfma_f32_32x32x16_bf16 v[48:63], v[88:91], v[176:179], v[48:63]
    ds_read_b64_tr_b16 v[84:85], v133 offset:20480
    ds_read_b64_tr_b16 v[86:87], v133 offset:21504
    v_cndmask_b32_dpp v115, v199, v195, vcc quad_perm:[1,0,3,2] row_mask:0xf bank_mask:0xf
    v_cndmask_b32_dpp v120, v204, v200, vcc quad_perm:[1,0,3,2] row_mask:0xf bank_mask:0xf
    v_cndmask_b32_dpp v121, v205, v201, vcc quad_perm:[1,0,3,2] row_mask:0xf bank_mask:0xf
    v_cndmask_b32_dpp v122, v206, v202, vcc quad_perm:[1,0,3,2] row_mask:0xf bank_mask:0xf
    v_mfma_f32_32x32x16_bf16 v[64:79], v[92:95], v[176:179], v[64:79]
    ds_read_b64_tr_b16 v[88:89], v134 offset:20480
    ds_read_b64_tr_b16 v[90:91], v134 offset:21504
    v_cndmask_b32_dpp v123, v207, v203, vcc quad_perm:[1,0,3,2] row_mask:0xf bank_mask:0xf
    s_mov_b64 vcc, s[28:29]
    v_cndmask_b32_dpp v116, v192, v196, vcc quad_perm:[1,0,3,2] row_mask:0xf bank_mask:0xf
    v_cndmask_b32_dpp v117, v193, v197, vcc quad_perm:[1,0,3,2] row_mask:0xf bank_mask:0xf
    s_waitcnt lgkmcnt(10)
    v_mfma_f32_32x32x16_bf16 v[16:31], v[96:99], v[180:183], v[16:31]
    ds_read_b64_tr_b16 v[92:93], v135 offset:20480
    ds_read_b64_tr_b16 v[94:95], v135 offset:21504
    v_cndmask_b32_dpp v118, v194, v198, vcc quad_perm:[1,0,3,2] row_mask:0xf bank_mask:0xf
    v_cndmask_b32_dpp v119, v195, v199, vcc quad_perm:[1,0,3,2] row_mask:0xf bank_mask:0xf
    v_cndmask_b32_dpp v124, v200, v204, vcc quad_perm:[1,0,3,2] row_mask:0xf bank_mask:0xf
    v_cndmask_b32_dpp v125, v201, v205, vcc quad_perm:[1,0,3,2] row_mask:0xf bank_mask:0xf
    v_mfma_f32_32x32x16_bf16 v[32:47], v[100:103], v[180:183], v[32:47]
    ds_read_b64_tr_b16 v[96:97], v132 offset:22528
    ds_read_b64_tr_b16 v[98:99], v132 offset:23552
    v_cndmask_b32_dpp v126, v202, v206, vcc quad_perm:[1,0,3,2] row_mask:0xf bank_mask:0xf
    v_cndmask_b32_dpp v127, v203, v207, vcc quad_perm:[1,0,3,2] row_mask:0xf bank_mask:0xf
    s_mov_b64 vcc, s[30:31]
    v_cndmask_b32_dpp v192, v120, v112, vcc quad_perm:[2,3,0,1] row_mask:0xf bank_mask:0xf
    s_waitcnt lgkmcnt(10)
    v_mfma_f32_32x32x16_bf16 v[48:63], v[104:107], v[180:183], v[48:63]
    ds_read_b64_tr_b16 v[100:101], v133 offset:22528
    ds_read_b64_tr_b16 v[102:103], v133 offset:23552
    ds_read_b128 v[4:7], v1 offset:96
    v_cndmask_b32_dpp v193, v121, v113, vcc quad_perm:[2,3,0,1] row_mask:0xf bank_mask:0xf
    v_cndmask_b32_dpp v194, v122, v114, vcc quad_perm:[2,3,0,1] row_mask:0xf bank_mask:0xf
    v_cndmask_b32_dpp v195, v123, v115, vcc quad_perm:[2,3,0,1] row_mask:0xf bank_mask:0xf
    v_cndmask_b32_dpp v196, v124, v116, vcc quad_perm:[2,3,0,1] row_mask:0xf bank_mask:0xf
    v_mfma_f32_32x32x16_bf16 v[64:79], v[108:111], v[180:183], v[64:79]
    ds_read_b64_tr_b16 v[104:105], v134 offset:22528
    ds_read_b64_tr_b16 v[106:107], v134 offset:23552
    v_cndmask_b32_dpp v197, v125, v117, vcc quad_perm:[2,3,0,1] row_mask:0xf bank_mask:0xf
    v_cndmask_b32_dpp v198, v126, v118, vcc quad_perm:[2,3,0,1] row_mask:0xf bank_mask:0xf
    v_cndmask_b32_dpp v199, v127, v119, vcc quad_perm:[2,3,0,1] row_mask:0xf bank_mask:0xf
    s_mov_b64 vcc, s[32:33]
    s_waitcnt lgkmcnt(11)
    v_mfma_f32_32x32x16_bf16 v[16:31], v[80:83], v[184:187], v[16:31]
    ds_read_b64_tr_b16 v[108:109], v135 offset:22528
    ds_read_b64_tr_b16 v[110:111], v135 offset:23552
    v_cndmask_b32_dpp v200, v112, v120, vcc quad_perm:[2,3,0,1] row_mask:0xf bank_mask:0xf
    v_cndmask_b32_dpp v201, v113, v121, vcc quad_perm:[2,3,0,1] row_mask:0xf bank_mask:0xf
    v_cndmask_b32_dpp v202, v114, v122, vcc quad_perm:[2,3,0,1] row_mask:0xf bank_mask:0xf
    v_cndmask_b32_dpp v203, v115, v123, vcc quad_perm:[2,3,0,1] row_mask:0xf bank_mask:0xf
    v_mfma_f32_32x32x16_bf16 v[32:47], v[84:87], v[184:187], v[32:47]
    s_waitcnt lgkmcnt(4)
    v_or3_b32 v9, v4, v5, v6
    v_or_b32 v9, v9, v7
    s_nop 0
    v_readfirstlane_b32 s69, v9
    s_nop 0
    s_cmp_eq_u32 s69, 0
    s_cbranch_scc0 Lslow_19
Lret_20:
    ds_read_b64_tr_b16 v[80:81], v132 offset:32768
    ds_read_b64_tr_b16 v[82:83], v132 offset:33792
    v_cndmask_b32_dpp v204, v116, v124, vcc quad_perm:[2,3,0,1] row_mask:0xf bank_mask:0xf
    v_cndmask_b32_dpp v205, v117, v125, vcc quad_perm:[2,3,0,1] row_mask:0xf bank_mask:0xf
    v_cndmask_b32_dpp v206, v118, v126, vcc quad_perm:[2,3,0,1] row_mask:0xf bank_mask:0xf
    v_cndmask_b32_dpp v207, v119, v127, vcc quad_perm:[2,3,0,1] row_mask:0xf bank_mask:0xf
    v_mfma_f32_32x32x16_bf16 v[48:63], v[88:91], v[184:187], v[48:63]
    ds_read_b64_tr_b16 v[84:85], v132 offset:34816
    ds_read_b64_tr_b16 v[86:87], v132 offset:35840
    ds_read_b128 v[4:7], v1 offset:112
    s_waitcnt vmcnt(0)
    s_mov_b64 vcc, s[26:27]
    v_cndmask_b32_dpp v112, v212, v208, vcc quad_perm:[1,0,3,2] row_mask:0xf bank_mask:0xf
    v_cndmask_b32_dpp v113, v213, v209, vcc quad_perm:[1,0,3,2] row_mask:0xf bank_mask:0xf
    v_cndmask_b32_dpp v114, v214, v210, vcc quad_perm:[1,0,3,2] row_mask:0xf bank_mask:0xf
    v_mfma_f32_32x32x16_bf16 v[64:79], v[92:95], v[184:187], v[64:79]
    ds_read_b64_tr_b16 v[88:89], v132 offset:36864
    ds_read_b64_tr_b16 v[90:91], v132 offset:37888
    v_cndmask_b32_dpp v115, v215, v211, vcc quad_perm:[1,0,3,2] row_mask:0xf bank_mask:0xf
    v_cndmask_b32_dpp v120, v220, v216, vcc quad_perm:[1,0,3,2] row_mask:0xf bank_mask:0xf
    v_cndmask_b32_dpp v121, v221, v217, vcc quad_perm:[1,0,3,2] row_mask:0xf bank_mask:0xf
    v_cndmask_b32_dpp v122, v222, v218, vcc quad_perm:[1,0,3,2] row_mask:0xf bank_mask:0xf
    v_mfma_f32_32x32x16_bf16 v[16:31], v[96:99], v[188:191], v[16:31]
    ds_read_b64_tr_b16 v[92:93], v132 offset:38912
    ds_read_b64_tr_b16 v[94:95], v132 offset:39936
    v_cndmask_b32_dpp v123, v223, v219, vcc quad_perm:[1,0,3,2] row_mask:0xf bank_mask:0xf
    s_mov_b64 vcc, s[28:29]
    v_cndmask_b32_dpp v116, v208, v212, vcc quad_perm:[1,0,3,2] row_mask:0xf bank_mask:0xf
    v_cndmask_b32_dpp v117, v209, v213, vcc quad_perm:[1,0,3,2] row_mask:0xf bank_mask:0xf
    v_mfma_f32_32x32x16_bf16 v[32:47], v[100:103], v[188:191], v[32:47]
    s_waitcnt lgkmcnt(4)
    v_or3_b32 v9, v4, v5, v6
    v_or_b32 v9, v9, v7
    s_nop 0
    v_readfirstlane_b32 s69, v9
    s_nop 0
    s_cmp_eq_u32 s69, 0
    s_cbranch_scc0 Lslow_22
Lret_23:
    ds_read_b64_tr_b16 v[96:97], v132 offset:49152
    ds_read_b64_tr_b16 v[98:99], v132 offset:50176
    v_cndmask_b32_dpp v118, v210, v214, vcc quad_perm:[1,0,3,2] row_mask:0xf bank_mask:0xf
    v_cndmask_b32_dpp v119, v211, v215, vcc quad_perm:[1,0,3,2] row_mask:0xf bank_mask:0xf
    v_cndmask_b32_dpp v124, v216, v220, vcc quad_perm:[1,0,3,2] row_mask:0xf bank_mask:0xf
    v_cndmask_b32_dpp v125, v217, v221, vcc quad_perm:[1,0,3,2] row_mask:0xf bank_mask:0xf
    v_mfma_f32_32x32x16_bf16 v[48:63], v[104:107], v[188:191], v[48:63]
    ds_read_b64_tr_b16 v[100:101], v132 offset:51200
    ds_read_b64_tr_b16 v[102:103], v132 offset:52224
    v_cndmask_b32_dpp v126, v218, v222, vcc quad_perm:[1,0,3,2] row_mask:0xf bank_mask:0xf
    v_cndmask_b32_dpp v127, v219, v223, vcc quad_perm:[1,0,3,2] row_mask:0xf bank_mask:0xf
    s_mov_b64 vcc, s[30:31]
    v_cndmask_b32_dpp v208, v120, v112, vcc quad_perm:[2,3,0,1] row_mask:0xf bank_mask:0xf
    v_mfma_f32_32x32x16_bf16 v[64:79], v[108:111], v[188:191], v[64:79]
    ds_read_b64_tr_b16 v[104:105], v132 offset:53248
    ds_read_b64_tr_b16 v[106:107], v132 offset:54272
    v_cndmask_b32_dpp v209, v121, v113, vcc quad_perm:[2,3,0,1] row_mask:0xf bank_mask:0xf
    v_cndmask_b32_dpp v210, v122, v114, vcc quad_perm:[2,3,0,1] row_mask:0xf bank_mask:0xf
    v_cndmask_b32_dpp v211, v123, v115, vcc quad_perm:[2,3,0,1] row_mask:0xf bank_mask:0xf
    v_cndmask_b32_dpp v212, v124, v116, vcc quad_perm:[2,3,0,1] row_mask:0xf bank_mask:0xf
    s_add_u32 m0, s75, 32
    s_mov_b64 exec, 1
    buffer_load_dword off, s[52:55], 0 lds
    s_mov_b64 exec, -1
    v_mfma_f32_32x32x16_bf16 v[16:31], v[80:83], v[192:195], v[16:31]
    ds_read_b64_tr_b16 v[108:109], v132 offset:55296
    ds_read_b64_tr_b16 v[110:111], v132 offset:56320
    v_cndmask_b32_dpp v213, v125, v117, vcc quad_perm:[2,3,0,1] row_mask:0xf bank_mask:0xf
    v_cndmask_b32_dpp v214, v126, v118, vcc quad_perm:[2,3,0,1] row_mask:0xf bank_mask:0xf
    v_cndmask_b32_dpp v215, v127, v119, vcc quad_perm:[2,3,0,1] row_mask:0xf bank_mask:0xf
    s_mov_b64 vcc, s[32:33]
    v_mfma_f32_32x32x16_bf16 v[16:31], v[84:87], v[196:199], v[16:31]
    ds_read_b64_tr_b16 v[80:81], v133 offset:32768
    ds_read_b64_tr_b16 v[82:83], v133 offset:33792
    v_cndmask_b32_dpp v216, v112, v120, vcc quad_perm:[2,3,0,1] row_mask:0xf bank_mask:0xf
    v_cndmask_b32_dpp v217, v113, v121, vcc quad_perm:[2,3,0,1] row_mask:0xf bank_mask:0xf
    v_cndmask_b32_dpp v218, v114, v122, vcc quad_perm:[2,3,0,1] row_mask:0xf bank_mask:0xf
    v_cndmask_b32_dpp v219, v115, v123, vcc quad_perm:[2,3,0,1] row_mask:0xf bank_mask:0xf
    s_waitcnt lgkmcnt(10)
    v_mfma_f32_32x32x16_bf16 v[16:31], v[88:91], v[200:203], v[16:31]
    ds_read_b64_tr_b16 v[84:85], v133 offset:34816
    ds_read_b64_tr_b16 v[86:87], v133 offset:35840
    v_cndmask_b32_dpp v220, v116, v124, vcc quad_perm:[2,3,0,1] row_mask:0xf bank_mask:0xf
    v_cndmask_b32_dpp v221, v117, v125, vcc quad_perm:[2,3,0,1] row_mask:0xf bank_mask:0xf
    v_cndmask_b32_dpp v222, v118, v126, vcc quad_perm:[2,3,0,1] row_mask:0xf bank_mask:0xf
    v_cndmask_b32_dpp v223, v119, v127, vcc quad_perm:[2,3,0,1] row_mask:0xf bank_mask:0xf
    v_mfma_f32_32x32x16_bf16 v[16:31], v[92:95], v[204:207], v[16:31]
    ds_read_b64_tr_b16 v[88:89], v133 offset:36864
    ds_read_b64_tr_b16 v[90:91], v133 offset:37888
    s_waitcnt lgkmcnt(10)
    v_mfma_f32_32x32x16_bf16 v[16:31], v[96:99], v[208:211], v[16:31]
    ds_read_b64_tr_b16 v[92:93], v133 offset:38912
    ds_read_b64_tr_b16 v[94:95], v133 offset:39936
    v_mfma_f32_32x32x16_bf16 v[16:31], v[100:103], v[212:215], v[16:31]
    ds_read_b64_tr_b16 v[96:97], v133 offset:49152
    ds_read_b64_tr_b16 v[98:99], v133 offset:50176
    s_waitcnt lgkmcnt(10)
    v_mfma_f32_32x32x16_bf16 v[16:31], v[104:107], v[216:219], v[16:31]
    ds_read_b64_tr_b16 v[100:101], v133 offset:51200
    ds_read_b64_tr_b16 v[102:103], v133 offset:52224
    v_mfma_f32_32x32x16_bf16 v[16:31], v[108:111], v[220:223], v[16:31]
    ds_read_b64_tr_b16 v[104:105], v133 offset:53248
    ds_read_b64_tr_b16 v[106:107], v133 offset:54272
    s_waitcnt lgkmcnt(10)
    v_mfma_f32_32x32x16_bf16 v[32:47], v[80:83], v[192:195], v[32:47]
    ds_read_b64_tr_b16 v[108:109], v133 offset:55296
    ds_read_b64_tr_b16 v[110:111], v133 offset:56320
    v_mfma_f32_32x32x16_bf16 v[32:47], v[84:87], v[196:199], v[32:47]
    ds_read_b64_tr_b16 v[80:81], v134 offset:32768
    ds_read_b64_tr_b16 v[82:83], v134 offset:33792
    s_waitcnt lgkmcnt(10)
    v_mfma_f32_32x32x16_bf16 v[32:47], v[88:91], v[200:203], v[32:47]
    ds_read_b64_tr_b16 v[84:85], v134 offset:34816
    ds_read_b64_tr_b16 v[86:87], v134 offset:35840
    v_cvt_pk_bf16_f32 v16, v16, v17
    v_cvt_pk_bf16_f32 v17, v18, v19
    v_cvt_pk_bf16_f32 v18, v20, v21
    v_mfma_f32_32x32x16_bf16 v[32:47], v[92:95], v[204:207], v[32:47]
    ds_read_b64_tr_b16 v[88:89], v134 offset:36864
    ds_read_b64_tr_b16 v[90:91], v134 offset:37888
    v_cvt_pk_bf16_f32 v19, v22, v23
    v_pk_max_i16 v16, v16, 0
    v_pk_max_i16 v17, v17, 0
    s_waitcnt lgkmcnt(10)
    v_mfma_f32_32x32x16_bf16 v[32:47], v[96:99], v[208:211], v[32:47]
    ds_read_b64_tr_b16 v[92:93], v134 offset:38912
    ds_read_b64_tr_b16 v[94:95], v134 offset:39936
    v_pk_max_i16 v18, v18, 0
    v_pk_max_i16 v19, v19, 0
    buffer_store_dwordx4 v[16:19], v3, s[56:59], s71 offen offset:0 sc1
    v_mfma_f32_32x32x16_bf16 v[32:47], v[100:103], v[212:215], v[32:47]
    ds_read_b64_tr_b16 v[96:97], v134 offset:49152
    ds_read_b64_tr_b16 v[98:99], v134 offset:50176
    v_cvt_pk_bf16_f32 v24, v24, v25
    v_cvt_pk_bf16_f32 v25, v26, v27
    v_cvt_pk_bf16_f32 v26, v28, v29
    s_waitcnt lgkmcnt(10)
    v_mfma_f32_32x32x16_bf16 v[32:47], v[104:107], v[216:219], v[32:47]
    ds_read_b64_tr_b16 v[100:101], v134 offset:51200
    ds_read_b64_tr_b16 v[102:103], v134 offset:52224
    v_cvt_pk_bf16_f32 v27, v30, v31
    v_pk_max_i16 v24, v24, 0
    v_pk_max_i16 v25, v25, 0
    v_mfma_f32_32x32x16_bf16 v[32:47], v[108:111], v[220:223], v[32:47]
    ds_read_b64_tr_b16 v[104:105], v134 offset:53248
    ds_read_b64_tr_b16 v[106:107], v134 offset:54272
    v_pk_max_i16 v26, v26, 0
    v_pk_max_i16 v27, v27, 0
    buffer_store_dwordx4 v[24:27], v3, s[56:59], s71 offen offset:2048 sc1
    s_waitcnt lgkmcnt(10)
    v_mfma_f32_32x32x16_bf16 v[48:63], v[80:83], v[192:195], v[48:63]
    ds_read_b64_tr_b16 v[108:109], v134 offset:55296
    ds_read_b64_tr_b16 v[110:111], v134 offset:56320
    v_mfma_f32_32x32x16_bf16 v[48:63], v[84:87], v[196:199], v[48:63]
    ds_read_b64_tr_b16 v[80:81], v135 offset:32768
    ds_read_b64_tr_b16 v[82:83], v135 offset:33792
    s_waitcnt lgkmcnt(10)
    v_mfma_f32_32x32x16_bf16 v[48:63], v[88:91], v[200:203], v[48:63]
    ds_read_b64_tr_b16 v[84:85], v135 offset:34816
    ds_read_b64_tr_b16 v[86:87], v135 offset:35840
    v_cvt_pk_bf16_f32 v32, v32, v33
    v_cvt_pk_bf16_f32 v33, v34, v35
    v_cvt_pk_bf16_f32 v34, v36, v37
    v_mfma_f32_32x32x16_bf16 v[48:63], v[92:95], v[204:207], v[48:63]
    ds_read_b64_tr_b16 v[88:89], v135 offset:36864
    ds_read_b64_tr_b16 v[90:91], v135 offset:37888
    v_cvt_pk_bf16_f32 v35, v38, v39
    v_pk_max_i16 v32, v32, 0
    v_pk_max_i16 v33, v33, 0
    s_waitcnt lgkmcnt(10)
    v_mfma_f32_32x32x16_bf16 v[48:63], v[96:99], v[208:211], v[48:63]
    ds_read_b64_tr_b16 v[92:93], v135 offset:38912
    ds_read_b64_tr_b16 v[94:95], v135 offset:39936
    v_pk_max_i16 v34, v34, 0
    v_pk_max_i16 v35, v35, 0
    s_add_u32 s71, s71, 4096
    buffer_store_dwordx4 v[32:35], v3, s[56:59], s71 offen offset:0 sc1
    v_mfma_f32_32x32x16_bf16 v[48:63], v[100:103], v[212:215], v[48:63]
    ds_read_b64_tr_b16 v[96:97], v135 offset:49152
    ds_read_b64_tr_b16 v[98:99], v135 offset:50176
    v_cvt_pk_bf16_f32 v40, v40, v41
    v_cvt_pk_bf16_f32 v41, v42, v43
    v_cvt_pk_bf16_f32 v42, v44, v45
    s_waitcnt lgkmcnt(10)
    v_mfma_f32_32x32x16_bf16 v[48:63], v[104:107], v[216:219], v[48:63]
    ds_read_b64_tr_b16 v[100:101], v135 offset:51200
    ds_read_b64_tr_b16 v[102:103], v135 offset:52224
    v_cvt_pk_bf16_f32 v43, v46, v47
    v_pk_max_i16 v40, v40, 0
    v_pk_max_i16 v41, v41, 0
    v_mfma_f32_32x32x16_bf16 v[48:63], v[108:111], v[220:223], v[48:63]
    ds_read_b64_tr_b16 v[104:105], v135 offset:53248
    ds_read_b64_tr_b16 v[106:107], v135 offset:54272
    v_pk_max_i16 v42, v42, 0
    v_pk_max_i16 v43, v43, 0
    buffer_store_dwordx4 v[40:43], v3, s[56:59], s71 offen offset:2048 sc1
    s_waitcnt lgkmcnt(10)
    v_mfma_f32_32x32x16_bf16 v[64:79], v[80:83], v[192:195], v[64:79]
    ds_read_b64_tr_b16 v[108:109], v135 offset:55296
    ds_read_b64_tr_b16 v[110:111], v135 offset:56320
    v_mfma_f32_32x32x16_bf16 v[64:79], v[84:87], v[196:199], v[64:79]
    s_waitcnt lgkmcnt(8)
    v_mfma_f32_32x32x16_bf16 v[64:79], v[88:91], v[200:203], v[64:79]
    v_cvt_pk_bf16_f32 v48, v48, v49
    v_cvt_pk_bf16_f32 v49, v50, v51
    v_cvt_pk_bf16_f32 v50, v52, v53
    v_mfma_f32_32x32x16_bf16 v[64:79], v[92:95], v[204:207], v[64:79]
    v_cvt_pk_bf16_f32 v51, v54, v55
    v_pk_max_i16 v48, v48, 0
    v_pk_max_i16 v49, v49, 0
    s_waitcnt lgkmcnt(4)
    v_mfma_f32_32x32x16_bf16 v[64:79], v[96:99], v[208:211], v[64:79]
    v_pk_max_i16 v50, v50, 0
    v_pk_max_i16 v51, v51, 0
    s_add_u32 s71, s71, 4096
    buffer_store_dwordx4 v[48:51], v3, s[56:59], s71 offen offset:0 sc1
    v_mfma_f32_32x32x16_bf16 v[64:79], v[100:103], v[212:215], v[64:79]
    v_cvt_pk_bf16_f32 v56, v56, v57
    v_cvt_pk_bf16_f32 v57, v58, v59
    v_cvt_pk_bf16_f32 v58, v60, v61
    s_waitcnt lgkmcnt(0)
    v_mfma_f32_32x32x16_bf16 v[64:79], v[104:107], v[216:219], v[64:79]
    v_cvt_pk_bf16_f32 v59, v62, v63
    v_pk_max_i16 v56, v56, 0
    v_pk_max_i16 v57, v57, 0
    v_mfma_f32_32x32x16_bf16 v[64:79], v[108:111], v[220:223], v[64:79]
    v_pk_max_i16 v58, v58, 0
    v_pk_max_i16 v59, v59, 0
    buffer_store_dwordx4 v[56:59], v3, s[56:59], s71 offen offset:2048 sc1
    s_add_u32 m0, s75, 48
    s_mov_b64 exec, 1
    buffer_load_dword off, s[52:55], 0 lds
    s_mov_b64 exec, -1
    s_setprio 0
    ds_read_b128 v[4:7], v1 offset:160
    s_waitcnt lgkmcnt(0)
    v_or3_b32 v9, v4, v5, v6
    v_or_b32 v9, v9, v7
    s_nop 0
    v_readfirstlane_b32 s69, v9
    s_nop 0
    s_cmp_eq_u32 s69, 0
    s_cbranch_scc0 Lslow_25
Lret_26:
    s_add_u32 m0, s15, 65536
    s_lshl_b32 s23, s40, 3
    buffer_load_dwordx4 v144, s[48:51], s23 offen offset:0 lds
    buffer_load_dwordx4 v145, s[48:51], s23 offen offset:1024 lds
    buffer_load_dwordx4 v146, s[48:51], s23 offen offset:2048 lds
    buffer_load_dwordx4 v147, s[48:51], s23 offen offset:3072 lds
    s_add_u32 m0, s15, 69632
    s_add_u32 s23, s23, 32768
    buffer_load_dwordx4 v144, s[48:51], s23 offen offset:0 lds
    buffer_load_dwordx4 v145, s[48:51], s23 offen offset:1024 lds
    buffer_load_dwordx4 v146, s[48:51], s23 offen offset:2048 lds
    buffer_load_dwordx4 v147, s[48:51], s23 offen offset:3072 lds
    v_cvt_pk_bf16_f32 v64, v64, v65
    v_cvt_pk_bf16_f32 v65, v66, v67
    v_cvt_pk_bf16_f32 v66, v68, v69
    v_cvt_pk_bf16_f32 v67, v70, v71
    v_pk_max_i16 v64, v64, 0
    v_pk_max_i16 v65, v65, 0
    v_pk_max_i16 v66, v66, 0
    v_pk_max_i16 v67, v67, 0
    s_add_u32 s71, s71, 4096
    buffer_store_dwordx4 v[64:67], v3, s[56:59], s71 offen offset:0 sc1
    v_cvt_pk_bf16_f32 v72, v72, v73
    v_cvt_pk_bf16_f32 v73, v74, v75
    v_cvt_pk_bf16_f32 v74, v76, v77
    v_cvt_pk_bf16_f32 v75, v78, v79
    v_pk_max_i16 v72, v72, 0
    v_pk_max_i16 v73, v73, 0
    v_pk_max_i16 v74, v74, 0
    v_pk_max_i16 v75, v75, 0
    buffer_store_dwordx4 v[72:75], v3, s[56:59], s71 offen offset:2048 sc1
    ds_read_b64 v[4:5], v1 offset:256
    s_waitcnt lgkmcnt(0)
    v_or_b32 v9, v4, v5
    s_nop 0
    v_readfirstlane_b32 s69, v9
    s_nop 0
    s_cmp_eq_u32 s69, 0
    s_cbranch_scc0 Lslow_28
Lret_29:
    ds_read_b64_tr_b16 v[224:225], v140 offset:0
    ds_read_b64_tr_b16 v[226:227], v140 offset:1024
    ds_read_b64_tr_b16 v[228:229], v141 offset:0
    ds_read_b64_tr_b16 v[230:231], v141 offset:1024
    ds_read_b64_tr_b16 v[232:233], v140 offset:2048
    ds_read_b64_tr_b16 v[234:235], v140 offset:3072
    ds_read_b64_tr_b16 v[236:237], v141 offset:2048
    ds_read_b64_tr_b16 v[238:239], v141 offset:3072
    ds_read_b64_tr_b16 v[240:241], v140 offset:4096
    ds_read_b64_tr_b16 v[242:243], v140 offset:5120
    ds_read_b64_tr_b16 v[244:245], v141 offset:4096
    ds_read_b64_tr_b16 v[246:247], v141 offset:5120
    ds_read_b64_tr_b16 v[248:249], v140 offset:6144
    ds_read_b64_tr_b16 v[250:251], v140 offset:7168
    ds_read_b64_tr_b16 v[252:253], v141 offset:6144
    ds_read_b64_tr_b16 v[254:255], v141 offset:7168
    ds_read_b64_tr_b16 v[160:161], v140 offset:32768
    ds_read_b64_tr_b16 v[162:163], v140 offset:33792
    ds_read_b64_tr_b16 v[164:165], v141 offset:32768
    ds_read_b64_tr_b16 v[166:167], v141 offset:33792
    ds_read_b64_tr_b16 v[168:169], v140 offset:34816
    ds_read_b64_tr_b16 v[170:171], v140 offset:35840
    ds_read_b64_tr_b16 v[172:173], v141 offset:34816
    ds_read_b64_tr_b16 v[174:175], v141 offset:35840
    ds_read_b64_tr_b16 v[176:177], v140 offset:36864
    ds_read_b64_tr_b16 v[178:179], v140 offset:37888
    ds_read_b64_tr_b16 v[180:181], v141 offset:36864
    ds_read_b64_tr_b16 v[182:183], v141 offset:37888
    ds_read_b64_tr_b16 v[184:185], v140 offset:38912
    ds_read_b64_tr_b16 v[186:187], v140 offset:39936
    ds_read_b64_tr_b16 v[188:189], v141 offset:38912
    ds_read_b64_tr_b16 v[190:191], v141 offset:39936
    s_waitcnt lgkmcnt(15)
    s_add_u32 m0, s15, 0
    s_lshl_b32 s23, s42, 3
    buffer_load_dwordx4 v144, s[48:51], s23 offen offset:0 lds
    buffer_load_dwordx4 v145, s[48:51], s23 offen offset:1024 lds
    buffer_load_dwordx4 v146, s[48:51], s23 offen offset:2048 lds
    buffer_load_dwordx4 v147, s[48:51], s23 offen offset:3072 lds
    s_add_u32 m0, s15, 4096
    s_add_u32 s23, s23, 32768
    buffer_load_dwordx4 v144, s[48:51], s23 offen offset:0 lds
    buffer_load_dwordx4 v145, s[48:51], s23 offen offset:1024 lds
    buffer_load_dwordx4 v146, s[48:51], s23 offen offset:2048 lds
    buffer_load_dwordx4 v147, s[48:51], s23 offen offset:3072 lds
    s_waitcnt vmcnt(10)
    ds_read_b64_tr_b16 v[192:193], v142 offset:0
    ds_read_b64_tr_b16 v[194:195], v142 offset:1024
    ds_read_b64_tr_b16 v[196:197], v143 offset:0
    ds_read_b64_tr_b16 v[198:199], v143 offset:1024
    ds_read_b64_tr_b16 v[200:201], v142 offset:2048
    ds_read_b64_tr_b16 v[202:203], v142 offset:3072
    ds_read_b64_tr_b16 v[204:205], v143 offset:2048
    ds_read_b64_tr_b16 v[206:207], v143 offset:3072
    ds_read_b64_tr_b16 v[208:209], v142 offset:4096
    ds_read_b64_tr_b16 v[210:211], v142 offset:5120
    ds_read_b64_tr_b16 v[212:213], v143 offset:4096
    ds_read_b64_tr_b16 v[214:215], v143 offset:5120
    ds_read_b64_tr_b16 v[216:217], v142 offset:6144
    ds_read_b64_tr_b16 v[218:219], v142 offset:7168
    ds_read_b64_tr_b16 v[220:221], v143 offset:6144
    ds_read_b64_tr_b16 v[222:223], v143 offset:7168
    s_waitcnt lgkmcnt(0)
    s_waitcnt vmcnt(8)
    s_buffer_atomic_swap s13, s[56:59], s35
    s_add_u32 s69, s35, 4096
    s_buffer_atomic_swap s13, s[56:59], s69
    s_add_u32 s69, s35, 8192
    s_buffer_atomic_swap s13, s[56:59], s69
    s_add_u32 s69, s35, 12288
    s_buffer_atomic_swap s13, s[56:59], s69
    s_add_u32 m0, s15, 32768
    s_lshl_b32 s23, s43, 3
    buffer_load_dwordx4 v144, s[48:51], s23 offen offset:0 lds
    buffer_load_dwordx4 v145, s[48:51], s23 offen offset:1024 lds
    buffer_load_dwordx4 v146, s[48:51], s23 offen offset:2048 lds
    buffer_load_dwordx4 v147, s[48:51], s23 offen offset:3072 lds
    s_add_u32 m0, s15, 36864
    s_add_u32 s23, s23, 32768
    buffer_load_dwordx4 v144, s[48:51], s23 offen offset:0 lds
    buffer_load_dwordx4 v145, s[48:51], s23 offen offset:1024 lds
    buffer_load_dwordx4 v146, s[48:51], s23 offen offset:2048 lds
    buffer_load_dwordx4 v147, s[48:51], s23 offen offset:3072 lds
    s_add_u32 m0, s15, 65536
    s_lshl_b32 s23, s34, 3
    buffer_load_dwordx4 v144, s[48:51], s23 offen offset:0 lds
    buffer_load_dwordx4 v145, s[48:51], s23 offen offset:1024 lds
    buffer_load_dwordx4 v146, s[48:51], s23 offen offset:2048 lds
    buffer_load_dwordx4 v147, s[48:51], s23 offen offset:3072 lds
    s_add_u32 m0, s15, 69632
    s_add_u32 s23, s23, 32768
    buffer_load_dwordx4 v144, s[48:51], s23 offen offset:0 lds
    buffer_load_dwordx4 v145, s[48:51], s23 offen offset:1024 lds
    buffer_load_dwordx4 v146, s[48:51], s23 offen offset:2048 lds
    buffer_load_dwordx4 v147, s[48:51], s23 offen offset:3072 lds
    ds_read_b128 v[4:7], v1 offset:176
    s_waitcnt lgkmcnt(0)
    v_or3_b32 v9, v4, v5, v6
    v_or_b32 v9, v9, v7
    s_nop 0
    v_readfirstlane_b32 s69, v9
    s_nop 0
    s_cmp_eq_u32 s69, 0
    s_cbranch_scc0 Lslow_31
Lret_32:
    s_buffer_load_dwordx8 s[24:31], s[56:59], s44 glc
    s_add_u32 m0, s15, 98304
    s_lshl_b32 s23, s41, 3
    buffer_load_dwordx4 v144, s[48:51], s23 offen offset:0 lds
    buffer_load_dwordx4 v145, s[48:51], s23 offen offset:1024 lds
    buffer_load_dwordx4 v146, s[48:51], s23 offen offset:2048 lds
    buffer_load_dwordx4 v147, s[48:51], s23 offen offset:3072 lds
    s_add_u32 m0, s15, 102400
    s_add_u32 s23, s23, 32768
    buffer_load_dwordx4 v144, s[48:51], s23 offen offset:0 lds
    buffer_load_dwordx4 v145, s[48:51], s23 offen offset:1024 lds
    buffer_load_dwordx4 v146, s[48:51], s23 offen offset:2048 lds
    buffer_load_dwordx4 v147, s[48:51], s23 offen offset:3072 lds
    s_mov_b32 s60, s16
    s_mov_b32 s61, s17
    s_mov_b32 s62, 0x200000
    s_mov_b32 s63, 0x20000
    s_mov_b32 s66, s13
    s_mov_b32 s67, s13
    s_waitcnt lgkmcnt(0)
    s_mov_b32 s37, 0
    s_cmp_lg_u64 s[24:25], s[66:67]
    s_cselect_b32 s69, 1, 0
    s_or_b32 s37, s37, s69
    s_cmp_lg_u64 s[26:27], s[66:67]
    s_cselect_b32 s69, 2, 0
    s_or_b32 s37, s37, s69
    s_cmp_lg_u64 s[28:29], s[66:67]
    s_cselect_b32 s69, 4, 0
    s_or_b32 s37, s37, s69
    s_cmp_lg_u64 s[30:31], s[66:67]
    s_cselect_b32 s69, 8, 0
    s_or_b32 s37, s37, s69
    s_branch L_G_gap3
    s_branch L_G_gap2
    s_branch L_G_gap
L_Gn:
    s_xor_b32 s66, s66, 262144
    buffer_load_dwordx4 v[240:243], v18, s[48:51], s66 offen
    buffer_load_dwordx4 v[244:247], v19, s[48:51], s66 offen offset:1024
    s_branch L_G
L_G_nog1:
    v_lshl_add_u32 v9, v10, 2, v12
    v_lshl_add_u32 v9, v9, 7, v13
    v_lshrrev_b32 v12, 1, v12
    v_lshl_add_u32 v9, v12, 6, v9
    v_add_u32 v140, s15, v9
    v_xor_b32 v141, 64, v140
    v_add_u32 v142, 0x10000, v140
    v_add_u32 v143, 0x10000, v141
    v_lshrrev_b32 v16, 3, v0
    v_and_b32 v17, 7, v0
    v_bfe_u32 v9, v0, 4, 1
    v_lshlrev_b32 v9, 2, v9
    v_xor_b32 v9, v17, v9
    v_lshlrev_b32 v9, 4, v9
    v_lshl_add_u32 v9, v16, 10, v9
    s_mul_i32 s64, s3, 458752
    s_lshl_b32 s65, s9, 7
    s_add_u32 s64, s64, s65
    v_add_u32 v144, s64, v9
    v_add_u32 v145, 7168, v144
    v_add_u32 v146, 14336, v144
    v_add_u32 v147, 21504, v144
    s_lshr_b32 s64, s3, 1
    s_lshl1_add_u32 s64, s6, s64
    s_and_b32 s65, s3, 1
    s_lshl1_add_u32 s66, s7, s65
    s_lshl_b32 s35, s64, 7
    s_lshl2_add_u32 s35, s66, s35
    s_add_u32 s35, s35, 40960
    s_mul_i32 s71, s64, 229376
    s_lshl_b32 s66, s7, 14
    s_add_u32 s71, s71, s66
    s_lshl_b32 s65, s65, 10
    s_add_u32 s71, s71, s65
    s_add_u32 s71, s71, 6291456
    s_mul_i32 s64, s3, 7
    s_and_b32 s64, s64, 30
    s_lshl_b32 s65, s8, 5
    s_add_u32 s64, s64, s65
    s_lshl2_add_u32 s64, s64, 40960
    v_lshl_add_u32 v10, v17, 2, s64
    v_add_u32 v14, 4096, v3
    s_and_b32 s65, s9, 3
    s_lshl_b32 s65, s65, 12
    s_add_u32 s44, s64, s65
    s_mul_i32 s64, s8, 229376
    s_mul_i32 s65, s3, 57344
    s_add_u32 s64, s64, s65
    s_add_u32 s64, s64, 6291456
    v_add_u32 v12, s64, v3
    v_add_u32 v13, s64, v14
    s_cmp_eq_u32 s4, 7
    s_cselect_b32 s12, 0, s4
    s_lshl_b32 s38, s12, 13
    s_add_u32 s39, s38, 8192
    s_cmp_eq_u32 s39, 57344
    s_cmov_b32 s39, 0
    s_add_u32 s40, s39, 8192
    s_cmp_eq_u32 s40, 57344
    s_cmov_b32 s40, 0
    s_add_u32 s41, s40, 8192
    s_cmp_eq_u32 s41, 57344
    s_cmov_b32 s41, 0
    s_add_u32 s42, s41, 8192
    s_cmp_eq_u32 s42, 57344
    s_cmov_b32 s42, 0
    s_add_u32 s43, s42, 8192
    s_cmp_eq_u32 s43, 57344
    s_cmov_b32 s43, 0
    s_add_u32 s34, s43, 8192
    s_cmp_eq_u32 s34, 57344
    s_cmov_b32 s34, 0
    s_mul_i32 s64, s3, 7
    s_and_b32 s64, s64, 1
    s_mov_b32 s36, 0
    s_lshr_b32 s65, s38, 13
    s_add_u32 s65, s65, s64
    s_lshr_b32 s65, s65, 1
    s_bitset1_b32 s36, s65
    s_lshr_b32 s65, s39, 13
    s_add_u32 s65, s65, s64
    s_lshr_b32 s65, s65, 1
    s_bitset1_b32 s36, s65
    s_waitcnt lgkmcnt(0)
    s_mul_i32 s13, s74, 1664525
    s_add_u32 s13, s13, 1013904223
    v_mov_b32 v9, 0
    ds_write_b32 v2, v9 offset:32
    ds_write_b32 v2, v9 offset:176
    s_mov_b32 s48, s0
    s_mov_b32 s49, s1
    s_mov_b32 s50, 0x1c0000
    s_mov_b32 s51, 0x20000
    s_and_b32 s64, s5, 3
    s_lshl_b32 s64, s64, 14
    s_mul_i32 s65, s3, 458752
    s_add_u32 s67, s64, s65
    v_lshrrev_b32 v16, 3, v0
    v_and_b32 v17, 7, v0
    v_lshlrev_b32 v17, 4, v17
    v_lshl_add_u32 v16, v16, 10, v17
    s_lshl3_add_u32 s65, s38, s67
    buffer_load_dwordx4 v[32:35], v16, s[48:51], s65 offen offset:384
    s_lshl3_add_u32 s65, s38, s67
    s_add_u32 s65, s65, 8192
    buffer_load_dwordx4 v[36:39], v16, s[48:51], s65 offen offset:384
    s_lshl3_add_u32 s65, s39, s67
    buffer_load_dwordx4 v[40:43], v16, s[48:51], s65 offen offset:384
    s_lshl3_add_u32 s65, s39, s67
    s_add_u32 s65, s65, 8192
    buffer_load_dwordx4 v[44:47], v16, s[48:51], s65 offen offset:384
    s_lshl3_add_u32 s65, s40, s67
    buffer_load_dwordx4 v[48:51], v16, s[48:51], s65 offen offset:384
    s_lshl3_add_u32 s65, s40, s67
    s_add_u32 s65, s65, 8192
    buffer_load_dwordx4 v[52:55], v16, s[48:51], s65 offen offset:384
    s_lshl3_add_u32 s65, s41, s67
    buffer_load_dwordx4 v[56:59], v16, s[48:51], s65 offen offset:384
    s_lshl3_add_u32 s65, s41, s67
    s_add_u32 s65, s65, 8192
    buffer_load_dwordx4 v[60:63], v16, s[48:51], s65 offen offset:384
    s_waitcnt vmcnt(10)
    ds_read_b64_tr_b16 v[20:21], v18 offset:0
    ds_read_b64_tr_b16 v[22:23], v18 offset:512
    ds_read_b64_tr_b16 v[24:25], v18 offset:64
    ds_read_b64_tr_b16 v[26:27], v18 offset:576
    s_waitcnt lgkmcnt(0)
    buffer_store_dwordx4 v[20:23], v19, s[56:59], s45 offen offset:0 sc1
    buffer_store_dwordx4 v[24:27], v19, s[56:59], s45 offen offset:1024 sc1
    s_lshl3_add_u32 s65, s42, s67
    buffer_load_dwordx4 v[32:35], v16, s[48:51], s65 offen offset:384
    s_lshl3_add_u32 s65, s42, s67
    s_add_u32 s65, s65, 8192
    buffer_load_dwordx4 v[36:39], v16, s[48:51], s65 offen offset:384
    s_lshl3_add_u32 s65, s43, s67
    buffer_load_dwordx4 v[40:43], v16, s[48:51], s65 offen offset:384
    s_lshl3_add_u32 s65, s43, s67
    s_add_u32 s65, s65, 8192
    buffer_load_dwordx4 v[44:47], v16, s[48:51], s65 offen offset:384
    s_lshl3_add_u32 s65, s34, s67
    buffer_load_dwordx4 v[48:51], v16, s[48:51], s65 offen offset:384
    s_lshl3_add_u32 s65, s34, s67
    s_add_u32 s65, s65, 8192
    buffer_load_dwordx4 v[52:55], v16, s[48:51], s65 offen offset:384
    s_waitcnt vmcnt(6)
    v_mov_b32 v9, 0
    ds_write_b32 v2, v9 offset:64
    s_and_b32 s64, s5, 3
    s_lshl_b32 s64, s64, 14
    s_mul_i32 s65, s3, 458752
    s_add_u32 s67, s64, s65
    s_mov_b32 exec_lo, 0x00ffffff
    s_lshl3_add_u32 s65, s38, s67
    buffer_load_dwordx4 v[32:35], v3, s[48:51], s65 offen offset:0
    buffer_load_dwordx4 v[36:39], v3, s[48:51], s65 offen offset:1024
    s_waitcnt vmcnt(10)
    buffer_load_dwordx4 v[40:43], v3, s[48:51], s65 offen offset:2048
    buffer_load_dwordx4 v[44:47], v3, s[48:51], s65 offen offset:3072
    s_add_u32 s65, s65, 4096
    s_waitcnt vmcnt(10)
    buffer_load_dwordx4 v[48:51], v3, s[48:51], s65 offen offset:0
    buffer_load_dwordx4 v[52:55], v3, s[48:51], s65 offen offset:1024
    s_waitcnt vmcnt(10)
    buffer_load_dwordx4 v[56:59], v3, s[48:51], s65 offen offset:2048
    buffer_load_dwordx4 v[60:63], v3, s[48:51], s65 offen offset:3072
    s_add_u32 s65, s65, 4096
    s_waitcnt vmcnt(10)
    buffer_load_dwordx4 v[32:35], v3, s[48:51], s65 offen offset:0
    buffer_load_dwordx4 v[36:39], v3, s[48:51], s65 offen offset:1024
    s_waitcnt vmcnt(10)
    buffer_load_dwordx4 v[40:43], v3, s[48:51], s65 offen offset:2048
    buffer_load_dwordx4 v[44:47], v3, s[48:51], s65 offen offset:3072
    s_add_u32 s65, s65, 4096
    s_waitcnt vmcnt(10)
    buffer_load_dwordx4 v[48:51], v3, s[48:51], s65 offen offset:0
    buffer_load_dwordx4 v[52:55], v3, s[48:51], s65 offen offset:1024
    s_waitcnt vmcnt(10)
    buffer_load_dwordx4 v[56:59], v3, s[48:51], s65 offen offset:2048
    buffer_load_dwordx4 v[60:63], v3, s[48:51], s65 offen offset:3072
    s_waitcnt vmcnt(10)
    s_lshl3_add_u32 s65, s39, s67
    buffer_load_dwordx4 v[32:35], v3, s[48:51], s65 offen offset:0
    buffer_load_dwordx4 v[36:39], v3, s[48:51], s65 offen offset:1024
    s_waitcnt vmcnt(10)
    buffer_load_dwordx4 v[40:43], v3, s[48:51], s65 offen offset:2048
    buffer_load_dwordx4 v[44:47], v3, s[48:51], s65 offen offset:3072
    s_add_u32 s65, s65, 4096
    s_waitcnt vmcnt(10)
    buffer_load_dwordx4 v[48:51], v3, s[48:51], s65 offen offset:0
    buffer_load_dwordx4 v[52:55], v3, s[48:51], s65 offen offset:1024
    s_waitcnt vmcnt(10)
    buffer_load_dwordx4 v[56:59], v3, s[48:51], s65 offen offset:2048
    buffer_load_dwordx4 v[60:63], v3, s[48:51], s65 offen offset:3072
    s_add_u32 s65, s65, 4096
    s_waitcnt vmcnt(10)
    buffer_load_dwordx4 v[32:35], v3, s[48:51], s65 offen offset:0
    buffer_load_dwordx4 v[36:39], v3, s[48:51], s65 offen offset:1024
    s_waitcnt vmcnt(10)
    buffer_load_dwordx4 v[40:43], v3, s[48:51], s65 offen offset:2048
    buffer_load_dwordx4 v[44:47], v3, s[48:51], s65 offen offset:3072
    s_add_u32 s65, s65, 4096
    s_waitcnt vmcnt(10)
    buffer_load_dwordx4 v[48:51], v3, s[48:51], s65 offen offset:0
    buffer_load_dwordx4 v[52:55], v3, s[48:51], s65 offen offset:1024
    s_waitcnt vmcnt(10)
    buffer_load_dwordx4 v[56:59], v3, s[48:51], s65 offen offset:2048
    buffer_load_dwordx4 v[60:63], v3, s[48:51], s65 offen offset:3072
    s_waitcnt vmcnt(10)
    s_mov_b64 exec, -1
    ds_read_b32 v4, v1 offset:336
    s_waitcnt lgkmcnt(0)
    v_readfirstlane_b32 s69, v4
    s_nop 0
    s_cmp_ge_u32 s69, 1
    s_cbranch_scc0 Lslow_34
Lret_35:
    ds_read_b64 v[4:5], v1 offset:320
    s_waitcnt lgkmcnt(0)
    v_min_u32 v9, v4, v5
    s_nop 0
    v_readfirstlane_b32 s69, v9
    s_nop 0
    s_cmp_ge_u32 s69, 1
    s_cbranch_scc0 Lslow_37
Lret_38:
    s_add_u32 m0, s15, 0
    s_lshl_b32 s23, s38, 3
    buffer_load_dwordx4 v144, s[48:51], s23 offen offset:0 lds
    buffer_load_dwordx4 v145, s[48:51], s23 offen offset:1024 lds
    buffer_load_dwordx4 v146, s[48:51], s23 offen offset:2048 lds
    buffer_load_dwordx4 v147, s[48:51], s23 offen offset:3072 lds
    s_add_u32 m0, s15, 4096
    s_add_u32 s23, s23, 32768
    buffer_load_dwordx4 v144, s[48:51], s23 offen offset:0 lds
    buffer_load_dwordx4 v145, s[48:51], s23 offen offset:1024 lds
    buffer_load_dwordx4 v146, s[48:51], s23 offen offset:2048 lds
    buffer_load_dwordx4 v147, s[48:51], s23 offen offset:3072 lds
    s_add_u32 m0, s15, 32768
    s_lshl_b32 s23, s39, 3
    buffer_load_dwordx4 v144, s[48:51], s23 offen offset:0 lds
    buffer_load_dwordx4 v145, s[48:51], s23 offen offset:1024 lds
    buffer_load_dwordx4 v146, s[48:51], s23 offen offset:2048 lds
    buffer_load_dwordx4 v147, s[48:51], s23 offen offset:3072 lds
    s_add_u32 m0, s15, 36864
    s_add_u32 s23, s23, 32768
    buffer_load_dwordx4 v144, s[48:51], s23 offen offset:0 lds
    buffer_load_dwordx4 v145, s[48:51], s23 offen offset:1024 lds
    buffer_load_dwordx4 v146, s[48:51], s23 offen offset:2048 lds
    buffer_load_dwordx4 v147, s[48:51], s23 offen offset:3072 lds
    s_add_u32 m0, s15, 65536
    s_lshl_b32 s23, s40, 3
    buffer_load_dwordx4 v144, s[48:51], s23 offen offset:0 lds
    buffer_load_dwordx4 v145, s[48:51], s23 offen offset:1024 lds
    buffer_load_dwordx4 v146, s[48:51], s23 offen offset:2048 lds
    buffer_load_dwordx4 v147, s[48:51], s23 offen offset:3072 lds
    s_add_u32 m0, s15, 69632
    s_add_u32 s23, s23, 32768
    buffer_load_dwordx4 v144, s[48:51], s23 offen offset:0 lds
    buffer_load_dwordx4 v145, s[48:51], s23 offen offset:1024 lds
    buffer_load_dwordx4 v146, s[48:51], s23 offen offset:2048 lds
    buffer_load_dwordx4 v147, s[48:51], s23 offen offset:3072 lds
    s_add_u32 m0, s15, 98304
    s_lshl_b32 s23, s41, 3
    buffer_load_dwordx4 v144, s[48:51], s23 offen offset:0 lds
    buffer_load_dwordx4 v145, s[48:51], s23 offen offset:1024 lds
    buffer_load_dwordx4 v146, s[48:51], s23 offen offset:2048 lds
    buffer_load_dwordx4 v147, s[48:51], s23 offen offset:3072 lds
    s_add_u32 m0, s15, 102400
    s_add_u32 s23, s23, 32768
    buffer_load_dwordx4 v144, s[48:51], s23 offen offset:0 lds
    buffer_load_dwordx4 v145, s[48:51], s23 offen offset:1024 lds
    buffer_load_dwordx4 v146, s[48:51], s23 offen offset:2048 lds
    buffer_load_dwordx4 v147, s[48:51], s23 offen offset:3072 lds
    s_waitcnt vmcnt(8)
    ds_read_b64_tr_b16 v[224:225], v140 offset:0
    ds_read_b64_tr_b16 v[226:227], v140 offset:1024
    ds_read_b64_tr_b16 v[228:229], v141 offset:0
    ds_read_b64_tr_b16 v[230:231], v141 offset:1024
    ds_read_b64_tr_b16 v[232:233], v140 offset:2048
    ds_read_b64_tr_b16 v[234:235], v140 offset:3072
    ds_read_b64_tr_b16 v[236:237], v141 offset:2048
    ds_read_b64_tr_b16 v[238:239], v141 offset:3072
    ds_read_b64_tr_b16 v[240:241], v140 offset:4096
    ds_read_b64_tr_b16 v[242:243], v140 offset:5120
    ds_read_b64_tr_b16 v[244:245], v141 offset:4096
    ds_read_b64_tr_b16 v[246:247], v141 offset:5120
    ds_read_b64_tr_b16 v[248:249], v140 offset:6144
    ds_read_b64_tr_b16 v[250:251], v140 offset:7168
    ds_read_b64_tr_b16 v[252:253], v141 offset:6144
    ds_read_b64_tr_b16 v[254:255], v141 offset:7168
    ds_read_b64_tr_b16 v[160:161], v140 offset:32768
    ds_read_b64_tr_b16 v[162:163], v140 offset:33792
    ds_read_b64_tr_b16 v[164:165], v141 offset:32768
    ds_read_b64_tr_b16 v[166:167], v141 offset:33792
    ds_read_b64_tr_b16 v[168:169], v140 offset:34816
    ds_read_b64_tr_b16 v[170:171], v140 offset:35840
    ds_read_b64_tr_b16 v[172:173], v141 offset:34816
    ds_read_b64_tr_b16 v[174:175], v141 offset:35840
    ds_read_b64_tr_b16 v[176:177], v140 offset:36864
    ds_read_b64_tr_b16 v[178:179], v140 offset:37888
    ds_read_b64_tr_b16 v[180:181], v141 offset:36864
    ds_read_b64_tr_b16 v[182:183], v141 offset:37888
    ds_read_b64_tr_b16 v[184:185], v140 offset:38912
    ds_read_b64_tr_b16 v[186:187], v140 offset:39936
    ds_read_b64_tr_b16 v[188:189], v141 offset:38912
    ds_read_b64_tr_b16 v[190:191], v141 offset:39936
    s_waitcnt lgkmcnt(0)
    ds_read_b64_tr_b16 v[192:193], v142 offset:0
    ds_read_b64_tr_b16 v[194:195], v142 offset:1024
    ds_read_b64_tr_b16 v[196:197], v143 offset:0
    ds_read_b64_tr_b16 v[198:199], v143 offset:1024
    ds_read_b64_tr_b16 v[200:201], v142 offset:2048
    ds_read_b64_tr_b16 v[202:203], v142 offset:3072
    ds_read_b64_tr_b16 v[204:205], v143 offset:2048
    ds_read_b64_tr_b16 v[206:207], v143 offset:3072
    ds_read_b64_tr_b16 v[208:209], v142 offset:4096
    ds_read_b64_tr_b16 v[210:211], v142 offset:5120
    ds_read_b64_tr_b16 v[212:213], v143 offset:4096
    ds_read_b64_tr_b16 v[214:215], v143 offset:5120
    ds_read_b64_tr_b16 v[216:217], v142 offset:6144
    ds_read_b64_tr_b16 v[218:219], v142 offset:7168
    ds_read_b64_tr_b16 v[220:221], v143 offset:6144
    ds_read_b64_tr_b16 v[222:223], v143 offset:7168
    s_add_u32 m0, s15, 0
    s_lshl_b32 s23, s42, 3
    buffer_load_dwordx4 v144, s[48:51], s23 offen offset:0 lds
    buffer_load_dwordx4 v145, s[48:51], s23 offen offset:1024 lds
    buffer_load_dwordx4 v146, s[48:51], s23 offen offset:2048 lds
    buffer_load_dwordx4 v147, s[48:51], s23 offen offset:3072 lds
    s_add_u32 m0, s15, 4096
    s_add_u32 s23, s23, 32768
    buffer_load_dwordx4 v144, s[48:51], s23 offen offset:0 lds
    buffer_load_dwordx4 v145, s[48:51], s23 offen offset:1024 lds
    buffer_load_dwordx4 v146, s[48:51], s23 offen offset:2048 lds
    buffer_load_dwordx4 v147, s[48:51], s23 offen offset:3072 lds
    s_add_u32 m0, s15, 32768
    s_lshl_b32 s23, s43, 3
    buffer_load_dwordx4 v144, s[48:51], s23 offen offset:0 lds
    buffer_load_dwordx4 v145, s[48:51], s23 offen offset:1024 lds
    buffer_load_dwordx4 v146, s[48:51], s23 offen offset:2048 lds
    buffer_load_dwordx4 v147, s[48:51], s23 offen offset:3072 lds
    s_add_u32 m0, s15, 36864
    s_add_u32 s23, s23, 32768
    buffer_load_dwordx4 v144, s[48:51], s23 offen offset:0 lds
    buffer_load_dwordx4 v145, s[48:51], s23 offen offset:1024 lds
    buffer_load_dwordx4 v146, s[48:51], s23 offen offset:2048 lds
    buffer_load_dwordx4 v147, s[48:51], s23 offen offset:3072 lds
    s_waitcnt lgkmcnt(0)
    s_add_u32 m0, s15, 65536
    s_lshl_b32 s23, s34, 3
    buffer_load_dwordx4 v144, s[48:51], s23 offen offset:0 lds
    buffer_load_dwordx4 v145, s[48:51], s23 offen offset:1024 lds
    buffer_load_dwordx4 v146, s[48:51], s23 offen offset:2048 lds
    buffer_load_dwordx4 v147, s[48:51], s23 offen offset:3072 lds
    s_add_u32 m0, s15, 69632
    s_add_u32 s23, s23, 32768
    buffer_load_dwordx4 v144, s[48:51], s23 offen offset:0 lds
    buffer_load_dwordx4 v145, s[48:51], s23 offen offset:1024 lds
    buffer_load_dwordx4 v146, s[48:51], s23 offen offset:2048 lds
    buffer_load_dwordx4 v147, s[48:51], s23 offen offset:3072 lds
    s_and_b32 s64, s5, 3
    s_lshl_b32 s64, s64, 14
    s_mul_i32 s65, s3, 458752
    s_add_u32 s67, s64, s65
    s_mov_b32 exec_lo, 0x00ffffff
    s_mov_b64 exec, -1
    s_mov_b32 s60, s16
    s_mov_b32 s61, s17
    s_mov_b32 s62, 0x200000
    s_mov_b32 s63, 0x20000
    s_branch L_G_gap2
L_G_gap:
    s_mov_b32 s60, s16
    s_mov_b32 s61, s17
    s_mov_b32 s62, 0x200000
    s_mov_b32 s63, 0x20000
    s_add_u32 m0, s15, 65536
    s_lshl_b32 s23, s34, 3
    buffer_load_dwordx4 v144, s[48:51], s23 offen offset:0 lds
    buffer_load_dwordx4 v145, s[48:51], s23 offen offset:1024 lds
    buffer_load_dwordx4 v146, s[48:51], s23 offen offset:2048 lds
    buffer_load_dwordx4 v147, s[48:51], s23 offen offset:3072 lds
    s_add_u32 m0, s15, 69632
    s_add_u32 s23, s23, 32768
    buffer_load_dwordx4 v144, s[48:51], s23 offen offset:0 lds
    buffer_load_dwordx4 v145, s[48:51], s23 offen offset:1024 lds
    buffer_load_dwordx4 v146, s[48:51], s23 offen offset:2048 lds
    buffer_load_dwordx4 v147, s[48:51], s23 offen offset:3072 lds
L_G_gap2:
    s_mov_b32 s66, s13
    s_mov_b32 s67, s13
    s_mov_b32 s37, 15
L_G_gap3:
    s_and_b32 s69, s37, s36
    s_cbranch_scc1 Lhs_40
Lhr_41:
    s_setprio 1
    buffer_load_dwordx4 v[80:83], v12, s[56:59], s38 offen offset:0 sc1
    buffer_load_dwordx4 v[84:87], v12, s[56:59], s38 offen offset:1024 sc1
    buffer_load_dwordx4 v[88:91], v12, s[56:59], s38 offen offset:2048 sc1
    buffer_load_dwordx4 v[92:95], v12, s[56:59], s38 offen offset:3072 sc1
    buffer_load_dwordx4 v[96:99], v13, s[56:59], s38 offen offset:0 sc1
    buffer_load_dwordx4 v[100:103], v13, s[56:59], s38 offen offset:1024 sc1
    buffer_load_dwordx4 v[104:107], v13, s[56:59], s38 offen offset:2048 sc1
    buffer_load_dwordx4 v[108:111], v13, s[56:59], s38 offen offset:3072 sc1
    s_and_b32 s69, s37, 15
    s_cbranch_scc1 Lhs_43
Lhr_44:
    s_waitcnt vmcnt(7)
    v_mfma_f32_32x32x16_bf16 v[16:31], v[224:227], v[80:83], 0
    buffer_load_dwordx4 v[112:115], v12, s[56:59], s39 offen offset:0 sc1
    s_waitcnt vmcnt(7)
    v_mfma_f32_32x32x16_bf16 v[32:47], v[224:227], v[84:87], 0
    buffer_load_dwordx4 v[116:119], v12, s[56:59], s39 offen offset:1024 sc1
    v_mfma_f32_32x32x16_bf16 v[48:63], v[228:231], v[80:83], 0
    buffer_load_dwordx4 v[120:123], v12, s[56:59], s39 offen offset:2048 sc1
    v_mfma_f32_32x32x16_bf16 v[64:79], v[228:231], v[84:87], 0
    buffer_load_dwordx4 v[124:127], v12, s[56:59], s39 offen offset:3072 sc1
    s_waitcnt vmcnt(9)
    v_mfma_f32_32x32x16_bf16 v[16:31], v[232:235], v[88:91], v[16:31]
    buffer_load_dwordx4 v[128:131], v13, s[56:59], s39 offen offset:0 sc1
    s_waitcnt vmcnt(9)
    v_mfma_f32_32x32x16_bf16 v[32:47], v[232:235], v[92:95], v[32:47]
    buffer_load_dwordx4 v[132:135], v13, s[56:59], s39 offen offset:1024 sc1
    v_mfma_f32_32x32x16_bf16 v[48:63], v[236:239], v[88:91], v[48:63]
    buffer_load_dwordx4 v[144:147], v13, s[56:59], s39 offen offset:2048 sc1
    v_mfma_f32_32x32x16_bf16 v[64:79], v[236:239], v[92:95], v[64:79]
    buffer_load_dwordx4 v[148:151], v13, s[56:59], s39 offen offset:3072 sc1
    s_waitcnt vmcnt(11)
    v_mfma_f32_32x32x16_bf16 v[16:31], v[240:243], v[96:99], v[16:31]
    buffer_load_dwordx4 v[80:83], v12, s[56:59], s40 offen offset:0 sc1
    s_waitcnt vmcnt(11)
    v_mfma_f32_32x32x16_bf16 v[32:47], v[240:243], v[100:103], v[32:47]
    buffer_load_dwordx4 v[84:87], v12, s[56:59], s40 offen offset:1024 sc1
    v_mfma_f32_32x32x16_bf16 v[48:63], v[244:247], v[96:99], v[48:63]
    buffer_load_dwordx4 v[88:91], v12, s[56:59], s40 offen offset:2048 sc1
    v_mfma_f32_32x32x16_bf16 v[64:79], v[244:247], v[100:103], v[64:79]
    buffer_load_dwordx4 v[92:95], v12, s[56:59], s40 offen offset:3072 sc1
    s_waitcnt vmcnt(13)
    v_mfma_f32_32x32x16_bf16 v[16:31], v[248:251], v[104:107], v[16:31]
    s_waitcnt vmcnt(12)
    v_mfma_f32_32x32x16_bf16 v[32:47], v[248:251], v[108:111], v[32:47]
    buffer_load_dwordx4 v[96:99], v13, s[56:59], s40 offen offset:0 sc1
    v_mfma_f32_32x32x16_bf16 v[48:63], v[252:255], v[104:107], v[48:63]
    v_mfma_f32_32x32x16_bf16 v[64:79], v[252:255], v[108:111], v[64:79]
    buffer_load_dwordx4 v[100:103], v13, s[56:59], s40 offen offset:1024 sc1
    s_waitcnt vmcnt(13)
    v_mfma_f32_32x32x16_bf16 v[16:31], v[160:163], v[112:115], v[16:31]
    s_waitcnt vmcnt(12)
    v_mfma_f32_32x32x16_bf16 v[32:47], v[160:163], v[116:119], v[32:47]
    buffer_load_dwordx4 v[104:107], v13, s[56:59], s40 offen offset:2048 sc1
    v_mfma_f32_32x32x16_bf16 v[48:63], v[164:167], v[112:115], v[48:63]
    v_and_b32 v4, 31, v0
    v_lshrrev_b32 v5, 5, v0
    v_mfma_f32_32x32x16_bf16 v[64:79], v[164:167], v[116:119], v[64:79]
    buffer_load_dwordx4 v[108:111], v13, s[56:59], s40 offen offset:3072 sc1
    s_waitcnt vmcnt(13)
    v_mfma_f32_32x32x16_bf16 v[16:31], v[168:171], v[120:123], v[16:31]
    v_and_b32 v6, 7, v0
    v_xor_b32 v5, v5, v6
    s_waitcnt vmcnt(12)
    v_mfma_f32_32x32x16_bf16 v[32:47], v[168:171], v[124:127], v[32:47]
    buffer_load_dwordx4 v[112:115], v12, s[56:59], s41 offen offset:0 sc1
    v_mfma_f32_32x32x16_bf16 v[48:63], v[172:175], v[120:123], v[48:63]
    v_lshlrev_b32 v5, 4, v5
    v_lshl_add_u32 v5, v4, 8, v5
    v_mfma_f32_32x32x16_bf16 v[64:79], v[172:175], v[124:127], v[64:79]
    buffer_load_dwordx4 v[116:119], v12, s[56:59], s41 offen offset:1024 sc1
    s_waitcnt vmcnt(13)
    v_mfma_f32_32x32x16_bf16 v[16:31], v[176:179], v[128:131], v[16:31]
    v_add_u32 v248, s15, v5
    v_xor_b32 v249, 32, v248
    s_waitcnt vmcnt(12)
    v_mfma_f32_32x32x16_bf16 v[32:47], v[176:179], v[132:135], v[32:47]
    buffer_load_dwordx4 v[120:123], v12, s[56:59], s41 offen offset:2048 sc1
    v_mfma_f32_32x32x16_bf16 v[48:63], v[180:183], v[128:131], v[48:63]
    v_xor_b32 v250, 64, v248
    v_xor_b32 v251, 96, v248
    v_mfma_f32_32x32x16_bf16 v[64:79], v[180:183], v[132:135], v[64:79]
    buffer_load_dwordx4 v[124:127], v12, s[56:59], s41 offen offset:3072 sc1
    s_waitcnt vmcnt(13)
    v_mfma_f32_32x32x16_bf16 v[16:31], v[184:187], v[144:147], v[16:31]
    v_add_u32 v252, 98304, v248
    v_add_u32 v253, 98304, v249
    s_waitcnt vmcnt(12)
    v_mfma_f32_32x32x16_bf16 v[32:47], v[184:187], v[148:151], v[32:47]
    buffer_load_dwordx4 v[128:131], v13, s[56:59], s41 offen offset:0 sc1
    v_mfma_f32_32x32x16_bf16 v[48:63], v[188:191], v[144:147], v[48:63]
    v_add_u32 v254, 98304, v250
    v_add_u32 v255, 98304, v251
    v_mfma_f32_32x32x16_bf16 v[64:79], v[188:191], v[148:151], v[64:79]
    buffer_load_dwordx4 v[132:135], v13, s[56:59], s41 offen offset:1024 sc1
    s_waitcnt vmcnt(13)
    v_mfma_f32_32x32x16_bf16 v[16:31], v[192:195], v[80:83], v[16:31]
    s_waitcnt vmcnt(12)
    v_mfma_f32_32x32x16_bf16 v[32:47], v[192:195], v[84:87], v[32:47]
    buffer_load_dwordx4 v[144:147], v13, s[56:59], s41 offen offset:2048 sc1
    v_mfma_f32_32x32x16_bf16 v[48:63], v[196:199], v[80:83], v[48:63]
    v_mfma_f32_32x32x16_bf16 v[64:79], v[196:199], v[84:87], v[64:79]
    buffer_load_dwordx4 v[148:151], v13, s[56:59], s41 offen offset:3072 sc1
    s_waitcnt vmcnt(13)
    v_mfma_f32_32x32x16_bf16 v[16:31], v[200:203], v[88:91], v[16:31]
    s_waitcnt vmcnt(12)
    v_mfma_f32_32x32x16_bf16 v[32:47], v[200:203], v[92:95], v[32:47]
    buffer_load_dwordx4 v[80:83], v12, s[56:59], s42 offen offset:0 sc1
    v_mfma_f32_32x32x16_bf16 v[48:63], v[204:207], v[88:91], v[48:63]
    v_mfma_f32_32x32x16_bf16 v[64:79], v[204:207], v[92:95], v[64:79]
    buffer_load_dwordx4 v[84:87], v12, s[56:59], s42 offen offset:1024 sc1
    s_waitcnt vmcnt(13)
    v_mfma_f32_32x32x16_bf16 v[16:31], v[208:211], v[96:99], v[16:31]
    ds_read_b64_tr_b16 v[224:225], v142 offset:32768
    v_mov_b32 v7, 0
    ds_write_b32 v2, v7 offset:112
    s_waitcnt vmcnt(12)
    v_mfma_f32_32x32x16_bf16 v[32:47], v[208:211], v[100:103], v[32:47]
    buffer_load_dwordx4 v[88:91], v12, s[56:59], s42 offen offset:2048 sc1
    ds_read_b64_tr_b16 v[226:227], v142 offset:33792
    v_mfma_f32_32x32x16_bf16 v[48:63], v[212:215], v[96:99], v[48:63]
    ds_read_b64_tr_b16 v[228:229], v143 offset:32768
    v_mfma_f32_32x32x16_bf16 v[64:79], v[212:215], v[100:103], v[64:79]
    buffer_load_dwordx4 v[92:95], v12, s[56:59], s42 offen offset:3072 sc1
    ds_read_b64_tr_b16 v[230:231], v143 offset:33792
    s_waitcnt vmcnt(13)
    v_mfma_f32_32x32x16_bf16 v[16:31], v[216:219], v[104:107], v[16:31]
    ds_read_b64_tr_b16 v[232:233], v142 offset:34816
    s_waitcnt vmcnt(12)
    v_mfma_f32_32x32x16_bf16 v[32:47], v[216:219], v[108:111], v[32:47]
    buffer_load_dwordx4 v[96:99], v13, s[56:59], s42 offen offset:0 sc1
    ds_read_b64_tr_b16 v[234:235], v142 offset:35840
    v_mfma_f32_32x32x16_bf16 v[48:63], v[220:223], v[104:107], v[48:63]
    ds_read_b64_tr_b16 v[236:237], v143 offset:34816
    v_mfma_f32_32x32x16_bf16 v[64:79], v[220:223], v[108:111], v[64:79]
    buffer_load_dwordx4 v[100:103], v13, s[56:59], s42 offen offset:1024 sc1
    ds_read_b64_tr_b16 v[238:239], v143 offset:35840
    s_waitcnt lgkmcnt(4)
    s_waitcnt vmcnt(13)
    v_mfma_f32_32x32x16_bf16 v[16:31], v[224:227], v[112:115], v[16:31]
    ds_read_b64_tr_b16 v[240:241], v142 offset:36864
    s_waitcnt vmcnt(12)
    v_mfma_f32_32x32x16_bf16 v[32:47], v[224:227], v[116:119], v[32:47]
    buffer_load_dwordx4 v[104:107], v13, s[56:59], s42 offen offset:2048 sc1
    ds_read_b64_tr_b16 v[242:243], v142 offset:37888
    v_mfma_f32_32x32x16_bf16 v[48:63], v[228:231], v[112:115], v[48:63]
    ds_read_b64_tr_b16 v[244:245], v143 offset:36864
    v_mfma_f32_32x32x16_bf16 v[64:79], v[228:231], v[116:119], v[64:79]
    buffer_load_dwordx4 v[108:111], v13, s[56:59], s42 offen offset:3072 sc1
    ds_read_b64_tr_b16 v[246:247], v143 offset:37888
    s_waitcnt lgkmcnt(4)
    s_waitcnt vmcnt(13)
    v_mfma_f32_32x32x16_bf16 v[16:31], v[232:235], v[120:123], v[16:31]
    ds_read_b64_tr_b16 v[224:225], v142 offset:38912
    s_waitcnt vmcnt(12)
    v_mfma_f32_32x32x16_bf16 v[32:47], v[232:235], v[124:127], v[32:47]
    buffer_load_dwordx4 v[112:115], v12, s[56:59], s43 offen offset:0 sc1
    ds_read_b64_tr_b16 v[226:227], v142 offset:39936
    v_mfma_f32_32x32x16_bf16 v[48:63], v[236:239], v[120:123], v[48:63]
    ds_read_b64_tr_b16 v[228:229], v143 offset:38912
    v_mfma_f32_32x32x16_bf16 v[64:79], v[236:239], v[124:127], v[64:79]
    buffer_load_dwordx4 v[116:119], v12, s[56:59], s43 offen offset:2048 sc1
    ds_read_b64_tr_b16 v[230:231], v143 offset:39936
    s_waitcnt lgkmcnt(4)
    s_waitcnt vmcnt(13)
    v_mfma_f32_32x32x16_bf16 v[16:31], v[240:243], v[128:131], v[16:31]
    ds_read_b64_tr_b16 v[232:233], v140 offset:0
    s_waitcnt vmcnt(12)
    v_mfma_f32_32x32x16_bf16 v[32:47], v[240:243], v[132:135], v[32:47]
    buffer_load_dwordx4 v[120:123], v13, s[56:59], s43 offen offset:0 sc1
    ds_read_b64_tr_b16 v[234:235], v140 offset:1024
    v_mfma_f32_32x32x16_bf16 v[48:63], v[244:247], v[128:131], v[48:63]
    ds_read_b64_tr_b16 v[236:237], v141 offset:0
    v_mfma_f32_32x32x16_bf16 v[64:79], v[244:247], v[132:135], v[64:79]
    buffer_load_dwordx4 v[124:127], v13, s[56:59], s43 offen offset:2048 sc1
    ds_read_b64_tr_b16 v[238:239], v141 offset:1024
    s_waitcnt lgkmcnt(4)
    s_waitcnt vmcnt(13)
    v_mfma_f32_32x32x16_bf16 v[16:31], v[224:227], v[144:147], v[16:31]
    ds_read_b64_tr_b16 v[240:241], v140 offset:2048
    s_waitcnt vmcnt(12)
    v_mfma_f32_32x32x16_bf16 v[32:47], v[224:227], v[148:151], v[32:47]
    buffer_load_dwordx4 v[128:131], v12, s[56:59], s34 offen offset:0 sc1
    ds_read_b64_tr_b16 v[242:243], v140 offset:3072
    v_mfma_f32_32x32x16_bf16 v[48:63], v[228:231], v[144:147], v[48:63]
    ds_read_b64_tr_b16 v[244:245], v141 offset:2048
    v_mfma_f32_32x32x16_bf16 v[64:79], v[228:231], v[148:151], v[64:79]
    buffer_load_dwordx4 v[132:135], v12, s[56:59], s34 offen offset:2048 sc1
    ds_read_b64_tr_b16 v[246:247], v141 offset:3072
    s_waitcnt lgkmcnt(4)
    s_waitcnt vmcnt(13)
    v_mfma_f32_32x32x16_bf16 v[16:31], v[232:235], v[80:83], v[16:31]
    ds_read_b64_tr_b16 v[224:225], v140 offset:4096
    s_waitcnt vmcnt(12)
    v_mfma_f32_32x32x16_bf16 v[32:47], v[232:235], v[84:87], v[32:47]
    buffer_load_dwordx4 v[144:147], v13, s[56:59], s34 offen offset:0 sc1
    ds_read_b64_tr_b16 v[226:227], v140 offset:5120
    v_mfma_f32_32x32x16_bf16 v[48:63], v[236:239], v[80:83], v[48:63]
    ds_read_b64_tr_b16 v[228:229], v141 offset:4096
    v_mfma_f32_32x32x16_bf16 v[64:79], v[236:239], v[84:87], v[64:79]
    buffer_load_dwordx4 v[148:151], v13, s[56:59], s34 offen offset:2048 sc1
    ds_read_b64_tr_b16 v[230:231], v141 offset:5120
    s_waitcnt lgkmcnt(4)
    s_waitcnt vmcnt(13)
    v_mfma_f32_32x32x16_bf16 v[16:31], v[240:243], v[88:91], v[16:31]
    ds_read_b64_tr_b16 v[232:233], v140 offset:6144
    s_waitcnt vmcnt(12)
    v_mfma_f32_32x32x16_bf16 v[32:47], v[240:243], v[92:95], v[32:47]
    buffer_load_dwordx4 v[80:83], v12, s[56:59], s43 offen offset:1024 sc1
    ds_read_b64_tr_b16 v[234:235], v140 offset:7168
    v_mfma_f32_32x32x16_bf16 v[48:63], v[244:247], v[88:91], v[48:63]
    ds_read_b64_tr_b16 v[236:237], v141 offset:6144
    v_mfma_f32_32x32x16_bf16 v[64:79], v[244:247], v[92:95], v[64:79]
    buffer_load_dwordx4 v[84:87], v12, s[56:59], s43 offen offset:3072 sc1
    ds_read_b64_tr_b16 v[238:239], v141 offset:7168
    s_waitcnt lgkmcnt(4)
    s_waitcnt vmcnt(13)
    v_mfma_f32_32x32x16_bf16 v[16:31], v[224:227], v[96:99], v[16:31]
    ds_read_b64_tr_b16 v[160:161], v140 offset:32768
    s_waitcnt vmcnt(12)
    v_mfma_f32_32x32x16_bf16 v[32:47], v[224:227], v[100:103], v[32:47]
    buffer_load_dwordx4 v[88:91], v13, s[56:59], s43 offen offset:1024 sc1
    ds_read_b64_tr_b16 v[162:163], v140 offset:33792
    v_mfma_f32_32x32x16_bf16 v[48:63], v[228:231], v[96:99], v[48:63]
    ds_read_b64_tr_b16 v[164:165], v141 offset:32768
    v_mfma_f32_32x32x16_bf16 v[64:79], v[228:231], v[100:103], v[64:79]
    buffer_load_dwordx4 v[92:95], v13, s[56:59], s43 offen offset:3072 sc1
    ds_read_b64_tr_b16 v[166:167], v141 offset:33792
    s_waitcnt lgkmcnt(4)
    s_waitcnt vmcnt(13)
    v_mfma_f32_32x32x16_bf16 v[16:31], v[232:235], v[104:107], v[16:31]
    ds_read_b64_tr_b16 v[168:169], v140 offset:34816
    ds_read_b64_tr_b16 v[170:171], v140 offset:35840
    s_waitcnt vmcnt(12)
    v_mfma_f32_32x32x16_bf16 v[32:47], v[232:235], v[108:111], v[32:47]
    buffer_load_dwordx4 v[96:99], v12, s[56:59], s34 offen offset:1024 sc1
    ds_read_b64_tr_b16 v[172:173], v141 offset:34816
    ds_read_b64_tr_b16 v[174:175], v141 offset:35840
    v_mfma_f32_32x32x16_bf16 v[48:63], v[236:239], v[104:107], v[48:63]
    ds_read_b64_tr_b16 v[176:177], v140 offset:36864
    ds_read_b64_tr_b16 v[178:179], v140 offset:37888
    v_mfma_f32_32x32x16_bf16 v[64:79], v[236:239], v[108:111], v[64:79]
    buffer_load_dwordx4 v[100:103], v12, s[56:59], s34 offen offset:3072 sc1
    ds_read_b64_tr_b16 v[180:181], v141 offset:36864
    ds_read_b64_tr_b16 v[182:183], v141 offset:37888
    s_waitcnt lgkmcnt(8)
    s_waitcnt vmcnt(13)
    v_mfma_f32_32x32x16_bf16 v[16:31], v[160:163], v[112:115], v[16:31]
    ds_read_b64_tr_b16 v[184:185], v140 offset:38912
    ds_read_b64_tr_b16 v[186:187], v140 offset:39936
    v_mfma_f32_32x32x16_bf16 v[48:63], v[164:167], v[112:115], v[48:63]
    buffer_load_dwordx4 v[104:107], v13, s[56:59], s34 offen offset:1024 sc1
    ds_read_b64_tr_b16 v[188:189], v141 offset:38912
    ds_read_b64_tr_b16 v[190:191], v141 offset:39936
    v_and_b32 v242, 7, v0
    v_lshrrev_b32 v240, 3, v0
    s_waitcnt lgkmcnt(8)
    s_waitcnt vmcnt(13)
    v_mfma_f32_32x32x16_bf16 v[16:31], v[168:171], v[116:119], v[16:31]
    ds_read_b64_tr_b16 v[192:193], v142 offset:0
    ds_read_b64_tr_b16 v[194:195], v142 offset:1024
    v_lshlrev_b32 v241, 1, v242
    v_xor_b32 v241, v241, v240
    v_mfma_f32_32x32x16_bf16 v[48:63], v[172:175], v[116:119], v[48:63]
    buffer_load_dwordx4 v[108:111], v13, s[56:59], s34 offen offset:3072 sc1
    ds_read_b64_tr_b16 v[196:197], v143 offset:0
    ds_read_b64_tr_b16 v[198:199], v143 offset:1024
    v_lshlrev_b32 v241, 4, v241
    v_lshl_add_u32 v241, v240, 8, v241
    s_waitcnt lgkmcnt(8)
    s_waitcnt vmcnt(13)
    v_mfma_f32_32x32x16_bf16 v[16:31], v[176:179], v[120:123], v[16:31]
    ds_read_b64_tr_b16 v[200:201], v142 offset:2048
    ds_read_b64_tr_b16 v[202:203], v142 offset:3072
    s_and_b32 s64, s3, 3
    s_lshl_b32 s64, s64, 11
    v_mfma_f32_32x32x16_bf16 v[48:63], v[180:183], v[120:123], v[48:63]
    ds_read_b64_tr_b16 v[204:205], v143 offset:2048
    ds_read_b64_tr_b16 v[206:207], v143 offset:3072
    s_cmp_lt_u32 s3, 4
    s_cselect_b32 s65, 98304, 0
    s_add_u32 s64, s64, s65
    s_waitcnt lgkmcnt(8)
    s_waitcnt vmcnt(12)
    v_mfma_f32_32x32x16_bf16 v[16:31], v[184:187], v[124:127], v[16:31]
    ds_read_b64_tr_b16 v[208:209], v142 offset:4096
    ds_read_b64_tr_b16 v[210:211], v142 offset:5120
    v_add_u32 v232, s64, v241
    v_xor_b32 v233, 16, v232
    v_mfma_f32_32x32x16_bf16 v[48:63], v[188:191], v[124:127], v[48:63]
    ds_read_b64_tr_b16 v[212:213], v143 offset:4096
    ds_read_b64_tr_b16 v[214:215], v143 offset:5120
    v_xor_b32 v241, v242, v240
    v_lshlrev_b32 v241, 4, v241
    s_waitcnt lgkmcnt(8)
    s_waitcnt vmcnt(11)
    v_mfma_f32_32x32x16_bf16 v[16:31], v[192:195], v[128:131], v[16:31]
    ds_read_b64_tr_b16 v[216:217], v142 offset:6144
    ds_read_b64_tr_b16 v[218:219], v142 offset:7168
    v_lshl_add_u32 v241, v240, 7, v241
    s_lshl_b32 s64, s3, 10
    v_mfma_f32_32x32x16_bf16 v[48:63], v[196:199], v[128:131], v[48:63]
    ds_read_b64_tr_b16 v[220:221], v143 offset:6144
    ds_read_b64_tr_b16 v[222:223], v143 offset:7168
    s_add_u32 s64, s64, 148480
    v_add_u32 v234, s64, v241
    s_waitcnt lgkmcnt(8)
    s_waitcnt vmcnt(10)
    v_mfma_f32_32x32x16_bf16 v[16:31], v[200:203], v[132:135], v[16:31]
    s_lshl_b32 s64, s3, 5
    s_add_u32 s64, s64, 163456
    v_mfma_f32_32x32x16_bf16 v[48:63], v[204:207], v[132:135], v[48:63]
    v_lshl_add_u32 v235, v240, 2, s64
    v_lshlrev_b32 v241, 4, v242
    s_waitcnt lgkmcnt(4)
    s_waitcnt vmcnt(9)
    v_mfma_f32_32x32x16_bf16 v[16:31], v[208:211], v[144:147], v[16:31]
    v_lshl_add_u32 v236, v240, 10, v241
    s_lshl3_add_u32 s64, s8, s3
    v_mfma_f32_32x32x16_bf16 v[48:63], v[212:215], v[144:147], v[48:63]
    s_lshl_b32 s64, s64, 13
    s_lshl_b32 s65, s9, 7
    s_waitcnt lgkmcnt(0)
    s_waitcnt vmcnt(8)
    v_mfma_f32_32x32x16_bf16 v[16:31], v[216:219], v[148:151], v[16:31]
    s_add_u32 s64, s64, s65
    v_add_u32 v236, s64, v236
    v_mfma_f32_32x32x16_bf16 v[48:63], v[220:223], v[148:151], v[48:63]
    s_waitcnt vmcnt(7)
    v_mfma_f32_32x32x16_bf16 v[32:47], v[160:163], v[80:83], v[32:47]
    s_nop 6
    ds_write_b128 v252, v[16:19] offset:0
    v_mfma_f32_32x32x16_bf16 v[64:79], v[164:167], v[80:83], v[64:79]
    s_waitcnt vmcnt(6)
    v_mfma_f32_32x32x16_bf16 v[32:47], v[168:171], v[84:87], v[32:47]
    ds_write_b128 v253, v[20:23] offset:0
    v_mfma_f32_32x32x16_bf16 v[64:79], v[172:175], v[84:87], v[64:79]
    s_waitcnt vmcnt(5)
    v_mfma_f32_32x32x16_bf16 v[32:47], v[176:179], v[88:91], v[32:47]
    ds_write_b128 v254, v[24:27] offset:0
    v_mfma_f32_32x32x16_bf16 v[64:79], v[180:183], v[88:91], v[64:79]
    s_waitcnt vmcnt(4)
    v_mfma_f32_32x32x16_bf16 v[32:47], v[184:187], v[92:95], v[32:47]
    ds_write_b128 v255, v[28:31] offset:0
    v_mfma_f32_32x32x16_bf16 v[64:79], v[188:191], v[92:95], v[64:79]
    s_waitcnt vmcnt(3)
    v_mfma_f32_32x32x16_bf16 v[32:47], v[192:195], v[96:99], v[32:47]
    ds_write_b128 v252, v[48:51] offset:128
    s_waitcnt vmcnt(2)
    v_mfma_f32_32x32x16_bf16 v[32:47], v[200:203], v[100:103], v[32:47]
    s_waitcnt vmcnt(1)
    v_mfma_f32_32x32x16_bf16 v[32:47], v[208:211], v[104:107], v[32:47]
    ds_write_b128 v253, v[52:55] offset:128
    s_waitcnt vmcnt(0)
    v_mfma_f32_32x32x16_bf16 v[32:47], v[216:219], v[108:111], v[32:47]
    v_mfma_f32_32x32x16_bf16 v[64:79], v[196:199], v[96:99], v[64:79]
    ds_write_b128 v254, v[56:59] offset:128
    v_mfma_f32_32x32x16_bf16 v[64:79], v[204:207], v[100:103], v[64:79]
    ds_write_b128 v255, v[60:63] offset:128
    v_mfma_f32_32x32x16_bf16 v[64:79], v[212:215], v[104:107], v[64:79]
    s_nop 6
    ds_write_b128 v248, v[32:35] offset:0
    v_mfma_f32_32x32x16_bf16 v[64:79], v[220:223], v[108:111], v[64:79]
    ds_write_b128 v249, v[36:39] offset:0
    ds_write_b128 v250, v[40:43] offset:0
    ds_write_b128 v251, v[44:47] offset:0
    s_nop 8
    ds_write_b128 v248, v[64:67] offset:128
    ds_write_b128 v249, v[68:71] offset:128
    ds_write_b128 v250, v[72:75] offset:128
    ds_write_b128 v251, v[76:79] offset:128
L_tail:
    s_setprio 0
    s_waitcnt lgkmcnt(0)
    s_barrier
    ds_read_b128 v[96:99], v232 offset:0
    ds_read_b128 v[100:103], v233 offset:0
    ds_read_b128 v[104:107], v232 offset:8192
    ds_read_b128 v[108:111], v233 offset:8192
    ds_read_b128 v[112:115], v232 offset:16384
    ds_read_b128 v[116:119], v233 offset:16384
    ds_read_b128 v[120:123], v232 offset:24576
    ds_read_b128 v[124:127], v233 offset:24576
    ds_read_b128 v[16:19], v234
    ds_read_b32 v24, v235
    s_waitcnt lgkmcnt(6)
    v_pk_add_f32 v[96:97], v[96:97], v[104:105]
    v_pk_add_f32 v[98:99], v[98:99], v[106:107]
    v_pk_add_f32 v[100:101], v[100:101], v[108:109]
    v_pk_add_f32 v[102:103], v[102:103], v[110:111]
    s_waitcnt lgkmcnt(2)
    v_pk_add_f32 v[112:113], v[112:113], v[120:121]
    v_pk_add_f32 v[114:115], v[114:115], v[122:123]
    v_pk_add_f32 v[116:117], v[116:117], v[124:125]
    v_pk_add_f32 v[118:119], v[118:119], v[126:127]
    v_pk_add_f32 v[96:97], v[96:97], v[112:113]
    v_pk_add_f32 v[98:99], v[98:99], v[114:115]
    v_pk_add_f32 v[100:101], v[100:101], v[116:117]
    v_pk_add_f32 v[102:103], v[102:103], v[118:119]
    v_cvt_pk_bf16_f32 v28, v96, v97
    v_cvt_pk_bf16_f32 v29, v98, v99
    v_cvt_pk_bf16_f32 v30, v100, v101
    v_cvt_pk_bf16_f32 v31, v102, v103
    s_waitcnt lgkmcnt(0)
    v_lshlrev_b32 v96, 16, v28
    v_and_b32 v97, 0xffff0000, v28
    v_lshlrev_b32 v98, 16, v29
    v_and_b32 v99, 0xffff0000, v29
    v_lshlrev_b32 v100, 16, v30
    v_and_b32 v101, 0xffff0000, v30
    v_lshlrev_b32 v102, 16, v31
    v_and_b32 v103, 0xffff0000, v31
    v_pk_mul_f32 v[96:97], v[96:97], v[24:25] op_sel_hi:[1,0]
    v_pk_mul_f32 v[98:99], v[98:99], v[24:25] op_sel_hi:[1,0]
    v_pk_mul_f32 v[100:101], v[100:101], v[24:25] op_sel_hi:[1,0]
    v_pk_mul_f32 v[102:103], v[102:103], v[24:25] op_sel_hi:[1,0]
    v_lshlrev_b32 v104, 16, v16
    v_and_b32 v105, 0xffff0000, v16
    v_lshlrev_b32 v106, 16, v17
    v_and_b32 v107, 0xffff0000, v17
    v_lshlrev_b32 v108, 16, v18
    v_and_b32 v109, 0xffff0000, v18
    v_lshlrev_b32 v110, 16, v19
    v_and_b32 v111, 0xffff0000, v19
    v_cvt_pk_bf16_f32 v28, v96, v97
    v_cvt_pk_bf16_f32 v29, v98, v99
    v_cvt_pk_bf16_f32 v30, v100, v101
    v_cvt_pk_bf16_f32 v31, v102, v103
    v_lshlrev_b32 v96, 16, v28
    v_and_b32 v97, 0xffff0000, v28
    v_lshlrev_b32 v98, 16, v29
    v_and_b32 v99, 0xffff0000, v29
    v_lshlrev_b32 v100, 16, v30
    v_and_b32 v101, 0xffff0000, v30
    v_lshlrev_b32 v102, 16, v31
    v_and_b32 v103, 0xffff0000, v31
    v_pk_add_f32 v[96:97], v[96:97], v[104:105]
    v_pk_add_f32 v[98:99], v[98:99], v[106:107]
    v_pk_add_f32 v[100:101], v[100:101], v[108:109]
    v_pk_add_f32 v[102:103], v[102:103], v[110:111]
    v_cvt_pk_bf16_f32 v36, v96, v97
    v_cvt_pk_bf16_f32 v37, v98, v99
    v_cvt_pk_bf16_f32 v38, v100, v101
    v_cvt_pk_bf16_f32 v39, v102, v103
    buffer_store_dwordx4 v[36:39], v236, s[60:63], 0 offen sc1
    s_endpgm
Lslow_1:
    s_mov_b32 s70, 524288
Lspin_3:
    ds_read_b128 v[4:7], v1 offset:0
    s_waitcnt lgkmcnt(0)
    v_or3_b32 v9, v4, v5, v6
    v_or_b32 v9, v9, v7
    s_nop 0
    v_readfirstlane_b32 s69, v9
    s_nop 0
    s_cmp_eq_u32 s69, 0
    s_cbranch_scc1 Lret_2
    s_sub_u32 s70, s70, 1
    s_cmp_lg_u32 s70, 0
    s_cbranch_scc1 Lspin_3
    s_branch Lret_2
Lslow_4:
    s_mov_b32 s70, 524288
Lspin_6:
    ds_read_b128 v[4:7], v1 offset:16
    s_waitcnt lgkmcnt(0)
    v_or3_b32 v9, v4, v5, v6
    v_or_b32 v9, v9, v7
    s_nop 0
    v_readfirstlane_b32 s69, v9
    s_nop 0
    s_cmp_eq_u32 s69, 0
    s_cbranch_scc1 Lret_5
    s_sub_u32 s70, s70, 1
    s_cmp_lg_u32 s70, 0
    s_cbranch_scc1 Lspin_6
    s_branch Lret_5
Lslow_7:
    s_mov_b32 s70, 524288
Lspin_9:
    ds_read_b128 v[4:7], v1 offset:32
    s_waitcnt lgkmcnt(0)
    v_or3_b32 v9, v4, v5, v6
    v_or_b32 v9, v9, v7
    s_nop 0
    v_readfirstlane_b32 s69, v9
    s_nop 0
    s_cmp_eq_u32 s69, 0
    s_cbranch_scc1 Lret_8
    s_sub_u32 s70, s70, 1
    s_cmp_lg_u32 s70, 0
    s_cbranch_scc1 Lspin_9
    s_branch Lret_8
Lslow_10:
    s_mov_b32 s70, 524288
Lspin_12:
    ds_read_b128 v[4:7], v1 offset:48
    s_waitcnt lgkmcnt(0)
    v_or3_b32 v9, v4, v5, v6
    v_or_b32 v9, v9, v7
    s_nop 0
    v_readfirstlane_b32 s69, v9
    s_nop 0
    s_cmp_eq_u32 s69, 0
    s_cbranch_scc1 Lret_11
    s_sub_u32 s70, s70, 1
    s_cmp_lg_u32 s70, 0
    s_cbranch_scc1 Lspin_12
    s_branch Lret_11
Lslow_13:
    s_mov_b32 s70, 524288
Lspin_15:
    ds_read_b128 v[4:7], v1 offset:64
    s_waitcnt lgkmcnt(0)
    v_or3_b32 v9, v4, v5, v6
    v_or_b32 v9, v9, v7
    s_nop 0
    v_readfirstlane_b32 s69, v9
    s_nop 0
    s_cmp_eq_u32 s69, 0
    s_cbranch_scc1 Lret_14
    s_sub_u32 s70, s70, 1
    s_cmp_lg_u32 s70, 0
    s_cbranch_scc1 Lspin_15
    s_branch Lret_14
Lslow_16:
    s_mov_b32 s70, 524288
Lspin_18:
    ds_read_b128 v[4:7], v1 offset:80
    s_waitcnt lgkmcnt(0)
    v_or3_b32 v9, v4, v5, v6
    v_or_b32 v9, v9, v7
    s_nop 0
    v_readfirstlane_b32 s69, v9
    s_nop 0
    s_cmp_eq_u32 s69, 0
    s_cbranch_scc1 Lret_17
    s_sub_u32 s70, s70, 1
    s_cmp_lg_u32 s70, 0
    s_cbranch_scc1 Lspin_18
    s_branch Lret_17
Lslow_19:
    s_mov_b32 s70, 524288
Lspin_21:
    ds_read_b128 v[4:7], v1 offset:96
    s_waitcnt lgkmcnt(0)
    v_or3_b32 v9, v4, v5, v6
    v_or_b32 v9, v9, v7
    s_nop 0
    v_readfirstlane_b32 s69, v9
    s_nop 0
    s_cmp_eq_u32 s69, 0
    s_cbranch_scc1 Lret_20
    s_sub_u32 s70, s70, 1
    s_cmp_lg_u32 s70, 0
    s_cbranch_scc1 Lspin_21
    s_branch Lret_20
Lslow_22:
    s_mov_b32 s70, 524288
Lspin_24:
    ds_read_b128 v[4:7], v1 offset:112
    s_waitcnt lgkmcnt(0)
    v_or3_b32 v9, v4, v5, v6
    v_or_b32 v9, v9, v7
    s_nop 0
    v_readfirstlane_b32 s69, v9
    s_nop 0
    s_cmp_eq_u32 s69, 0
    s_cbranch_scc1 Lret_23
    s_sub_u32 s70, s70, 1
    s_cmp_lg_u32 s70, 0
    s_cbranch_scc1 Lspin_24
    s_branch Lret_23
Lslow_25:
    s_mov_b32 s70, 524288
Lspin_27:
    ds_read_b128 v[4:7], v1 offset:160
    s_waitcnt lgkmcnt(0)
    v_or3_b32 v9, v4, v5, v6
    v_or_b32 v9, v9, v7
    s_nop 0
    v_readfirstlane_b32 s69, v9
    s_nop 0
    s_cmp_eq_u32 s69, 0
    s_cbranch_scc1 Lret_26
    s_sleep 1
    s_sub_u32 s70, s70, 1
    s_cmp_lg_u32 s70, 0
    s_cbranch_scc1 Lspin_27
    s_branch Lret_26
Lslow_28:
    s_waitcnt vmcnt(0)
    s_buffer_atomic_swap s13, s[56:59], s35
    s_add_u32 s69, s35, 4096
    s_buffer_atomic_swap s13, s[56:59], s69
    s_add_u32 s69, s35, 8192
    s_buffer_atomic_swap s13, s[56:59], s69
    s_add_u32 s69, s35, 12288
    s_buffer_atomic_swap s13, s[56:59], s69
    s_mov_b32 s70, 524288
Lspin_30:
    ds_read_b64 v[4:5], v1 offset:256
    s_waitcnt lgkmcnt(0)
    v_or_b32 v9, v4, v5
    s_nop 0
    v_readfirstlane_b32 s69, v9
    s_nop 0
    s_cmp_eq_u32 s69, 0
    s_cbranch_scc1 Lret_29
    s_sleep 1
    s_sub_u32 s70, s70, 1
    s_cmp_lg_u32 s70, 0
    s_cbranch_scc1 Lspin_30
    s_branch Lret_29
Lslow_31:
    s_mov_b32 s70, 524288
Lspin_33:
    ds_read_b128 v[4:7], v1 offset:176
    s_waitcnt lgkmcnt(0)
    v_or3_b32 v9, v4, v5, v6
    v_or_b32 v9, v9, v7
    s_nop 0
    v_readfirstlane_b32 s69, v9
    s_nop 0
    s_cmp_eq_u32 s69, 0
    s_cbranch_scc1 Lret_32
    s_sleep 1
    s_sub_u32 s70, s70, 1
    s_cmp_lg_u32 s70, 0
    s_cbranch_scc1 Lspin_33
    s_branch Lret_32
Lslow_34:
    s_mov_b32 s70, 524288
Lspin_36:
    ds_read_b32 v4, v1 offset:336
    s_waitcnt lgkmcnt(0)
    v_readfirstlane_b32 s69, v4
    s_nop 0
    s_cmp_ge_u32 s69, 1
    s_cbranch_scc1 Lret_35
    s_sleep 2
    s_sub_u32 s70, s70, 1
    s_cmp_lg_u32 s70, 0
    s_cbranch_scc1 Lspin_36
    s_branch Lret_35
Lslow_37:
    s_mov_b32 s70, 524288
Lspin_39:
    ds_read_b64 v[4:5], v1 offset:320
    s_waitcnt lgkmcnt(0)
    v_min_u32 v9, v4, v5
    s_nop 0
    v_readfirstlane_b32 s69, v9
    s_nop 0
    s_cmp_ge_u32 s69, 1
    s_cbranch_scc1 Lret_38
    s_sleep 1
    s_sub_u32 s70, s70, 1
    s_cmp_lg_u32 s70, 0
    s_cbranch_scc1 Lspin_39
    s_branch Lret_38
Lhs_40:
    s_mov_b32 s70, 524288
Lhl_42:
    s_buffer_load_dwordx8 s[24:31], s[56:59], s44 glc
    s_waitcnt lgkmcnt(0)
    s_mov_b32 s37, 0
    s_cmp_lg_u64 s[24:25], s[66:67]
    s_cselect_b32 s69, 1, 0
    s_or_b32 s37, s37, s69
    s_cmp_lg_u64 s[26:27], s[66:67]
    s_cselect_b32 s69, 2, 0
    s_or_b32 s37, s37, s69
    s_cmp_lg_u64 s[28:29], s[66:67]
    s_cselect_b32 s69, 4, 0
    s_or_b32 s37, s37, s69
    s_cmp_lg_u64 s[30:31], s[66:67]
    s_cselect_b32 s69, 8, 0
    s_or_b32 s37, s37, s69
    s_and_b32 s69, s37, s36
    s_cbranch_scc0 Lhr_41
    s_sleep 1
    s_sub_u32 s70, s70, 1
    s_cmp_lg_u32 s70, 0
    s_cbranch_scc1 Lhl_42
    s_branch Lhr_41
Lhs_43:
    s_mov_b32 s70, 524288
Lhl_45:
    s_buffer_load_dwordx8 s[24:31], s[56:59], s44 glc
    s_waitcnt lgkmcnt(0)
    s_mov_b32 s37, 0
    s_cmp_lg_u64 s[24:25], s[66:67]
    s_cselect_b32 s69, 1, 0
    s_or_b32 s37, s37, s69
    s_cmp_lg_u64 s[26:27], s[66:67]
    s_cselect_b32 s69, 2, 0
    s_or_b32 s37, s37, s69
    s_cmp_lg_u64 s[28:29], s[66:67]
    s_cselect_b32 s69, 4, 0
    s_or_b32 s37, s37, s69
    s_cmp_lg_u64 s[30:31], s[66:67]
    s_cselect_b32 s69, 8, 0
    s_or_b32 s37, s37, s69
    s_and_b32 s69, s37, 15
    s_cbranch_scc0 Lhr_44
    s_sleep 1
    s_sub_u32 s70, s70, 1
    s_cmp_lg_u32 s70, 0
    s_cbranch_scc1 Lhl_45
    s_branch Lhr_44
L_Ab:
    s_setprio 3
    s_cmp_eq_u32 s4, 7
    s_cselect_b32 s12, 0, s4
    s_mul_i32 s75, s15, 8704
    s_add_u32 s75, s75, 131072
    s_cmp_eq_u32 s3, 4
    s_cmov_b32 s75, 114688
    s_cmp_eq_u32 s3, 5
    s_cmov_b32 s75, 148480
    s_mov_b32 s56, s46
    s_mov_b32 s57, s47
    s_mov_b32 s58, 0x1000000
    s_mov_b32 s59, 0x20000
    s_mov_b32 s60, s44
    s_mov_b32 s61, s45
    s_mov_b32 s62, 0x100
    s_mov_b32 s63, 0x20000
    s_mov_b32 s34, 157696
    s_cmp_ge_u32 s3, 6
    s_cselect_b32 s35, 16, 0
    v_lshl_add_u32 v220, v0, 2, s75
    v_add_u32 v221, 1088, v220
    v_add_u32 v222, 2176, v220
    v_add_u32 v223, 3264, v220
    v_add_u32 v224, 4352, v220
    v_add_u32 v225, 5440, v220
    v_add_u32 v226, 6528, v220
    v_add_u32 v227, 7616, v220
    v_and_b32 v17, 31, v0
    v_mul_u32_u24 v19, 272, v17
    v_lshrrev_b32 v18, 5, v0
    v_lshl_add_u32 v19, v18, 4, v19
    v_add_u32 v228, s75, v19
    s_cmp_eq_u32 s15, 0
    s_cselect_b32 s64, 114688, s34
    v_lshl_add_u32 v22, v0, 4, s64
    v_lshlrev_b32 v19, 4, v17
    v_lshl_add_u32 v19, v18, 9, v19
    s_add_u32 s64, s75, 1008
    v_sub_u32 v23, s64, v19
    s_waitcnt vmcnt(0) lgkmcnt(0)
    s_mul_i32 s13, s74, 1664525
    s_add_u32 s13, s13, 1013904223
    v_lshlrev_b32 v8, 16, v8
    v_mul_f32 v8, 0x3fb8aa3b, v8
    v_exp_f32 v8, v8
    s_nop 0
    v_cvt_pk_bf16_f32 v8, v8, v8
    v_lshlrev_b32 v9, 16, v8
    v_lshlrev_b32 v16, s35, v2
    v_lshlrev_b32 v17, s35, v3
    v_lshlrev_b32 v18, s35, v4
    v_lshlrev_b32 v19, s35, v5
    v_lshlrev_b32 v20, s35, v6
    v_lshlrev_b32 v21, s35, v7
    v_and_b32 v16, 0xffff0000, v16
    v_and_b32 v17, 0xffff0000, v17
    v_and_b32 v18, 0xffff0000, v18
    v_and_b32 v19, 0xffff0000, v19
    v_and_b32 v20, 0xffff0000, v20
    v_and_b32 v21, 0xffff0000, v21
    v_mul_f32 v16, v9, v16
    v_mul_f32 v17, v9, v17
    v_mul_f32 v18, v9, v18
    v_mul_f32 v19, v9, v19
    v_mul_f32 v16, 0x3fb8aa3b, v16
    v_mul_f32 v17, 0.15915494, v17
    v_mul_f32 v212, 0x41000000, v16
    v_mul_f32 v213, 0x41000000, v17
    v_mul_f32 v214, 0x42800000, v16
    v_mul_f32 v215, 0x42800000, v17
    v_mul_f32 v216, 0x3f800000, v16
    v_mul_f32 v217, 0x3f800000, v17
    v_mul_f32 v218, 0x43800000, v16
    v_mul_f32 v219, 0x43800000, v17
    v_exp_f32 v212, v212
    v_fract_f32 v213, v213
    v_exp_f32 v214, v214
    v_fract_f32 v215, v215
    v_exp_f32 v216, v216
    v_fract_f32 v217, v217
    v_exp_f32 v218, v218
    v_fract_f32 v219, v219
    v_pk_mul_f32 v[136:137], v[18:19], v[20:21] op_sel:[0,0] op_sel_hi:[0,1]
    v_pk_fma_f32 v[136:137], v[18:19], v[20:21], v[136:137] op_sel:[1,1,0] op_sel_hi:[1,0,1] neg_lo:[1,0,0]
    v_cos_f32 v74, v213
    v_sin_f32 v75, v213
    v_cos_f32 v88, v215
    v_sin_f32 v89, v215
    v_cos_f32 v192, v217
    v_sin_f32 v193, v217
    v_cos_f32 v196, v219
    v_sin_f32 v197, v219
    v_mov_b32 v72, 1.0
    v_mov_b32 v73, 0
    v_mul_f32 v74, v74, v212
    v_mul_f32 v75, v75, v212
    v_mul_f32 v88, v88, v214
    v_mul_f32 v89, v89, v214
    v_mul_f32 v192, v192, v216
    v_mul_f32 v193, v193, v216
    v_mul_f32 v196, v196, v218
    v_mul_f32 v197, v197, v218
    v_pk_mul_f32 v[76:77], v[74:75], v[74:75] op_sel:[0,0] op_sel_hi:[0,1]
    v_pk_mul_f32 v[104:105], v[88:89], v[88:89] op_sel:[0,0] op_sel_hi:[0,1]
    v_pk_mul_f32 v[194:195], v[192:193], v[192:193] op_sel:[0,0] op_sel_hi:[0,1]
    v_pk_mul_f32 v[198:199], v[196:197], v[196:197] op_sel:[0,0] op_sel_hi:[0,1]
    v_pk_mul_f32 v[138:139], v[136:137], v[192:193] op_sel:[0,0] op_sel_hi:[0,1]
    v_pk_mul_f32 v[90:91], v[74:75], v[88:89] op_sel:[0,0] op_sel_hi:[0,1]
    v_pk_mul_f32 v[152:153], v[136:137], v[74:75] op_sel:[0,0] op_sel_hi:[0,1]
    v_pk_mul_f32 v[154:155], v[136:137], v[196:197] op_sel:[0,0] op_sel_hi:[0,1]
    v_pk_fma_f32 v[76:77], v[74:75], v[74:75], v[76:77] op_sel:[1,1,0] op_sel_hi:[1,0,1] neg_lo:[1,0,0]
    v_pk_fma_f32 v[104:105], v[88:89], v[88:89], v[104:105] op_sel:[1,1,0] op_sel_hi:[1,0,1] neg_lo:[1,0,0]
    v_pk_fma_f32 v[194:195], v[192:193], v[192:193], v[194:195] op_sel:[1,1,0] op_sel_hi:[1,0,1] neg_lo:[1,0,0]
    v_pk_fma_f32 v[198:199], v[196:197], v[196:197], v[198:199] op_sel:[1,1,0] op_sel_hi:[1,0,1] neg_lo:[1,0,0]
    v_pk_fma_f32 v[138:139], v[136:137], v[192:193], v[138:139] op_sel:[1,1,0] op_sel_hi:[1,0,1] neg_lo:[1,0,0]
    v_pk_fma_f32 v[90:91], v[74:75], v[88:89], v[90:91] op_sel:[1,1,0] op_sel_hi:[1,0,1] neg_lo:[1,0,0]
    v_pk_fma_f32 v[152:153], v[136:137], v[74:75], v[152:153] op_sel:[1,1,0] op_sel_hi:[1,0,1] neg_lo:[1,0,0]
    v_pk_fma_f32 v[154:155], v[136:137], v[196:197], v[154:155] op_sel:[1,1,0] op_sel_hi:[1,0,1] neg_lo:[1,0,0]
    v_pk_mul_f32 v[78:79], v[76:77], v[74:75] op_sel:[0,0] op_sel_hi:[0,1]
    v_pk_mul_f32 v[80:81], v[76:77], v[76:77] op_sel:[0,0] op_sel_hi:[0,1]
    v_pk_mul_f32 v[120:121], v[104:105], v[88:89] op_sel:[0,0] op_sel_hi:[0,1]
    v_pk_mul_f32 v[200:201], v[198:199], v[196:197] op_sel:[0,0] op_sel_hi:[0,1]
    v_pk_mul_f32 v[202:203], v[198:199], v[198:199] op_sel:[0,0] op_sel_hi:[0,1]
    v_pk_mul_f32 v[140:141], v[136:137], v[194:195] op_sel:[0,0] op_sel_hi:[0,1]
    v_pk_mul_f32 v[142:143], v[138:139], v[194:195] op_sel:[0,0] op_sel_hi:[0,1]
    v_pk_mul_f32 v[92:93], v[76:77], v[88:89] op_sel:[0,0] op_sel_hi:[0,1]
    v_pk_fma_f32 v[78:79], v[76:77], v[74:75], v[78:79] op_sel:[1,1,0] op_sel_hi:[1,0,1] neg_lo:[1,0,0]
    v_pk_fma_f32 v[80:81], v[76:77], v[76:77], v[80:81] op_sel:[1,1,0] op_sel_hi:[1,0,1] neg_lo:[1,0,0]
    v_pk_fma_f32 v[120:121], v[104:105], v[88:89], v[120:121] op_sel:[1,1,0] op_sel_hi:[1,0,1] neg_lo:[1,0,0]
    v_pk_fma_f32 v[200:201], v[198:199], v[196:197], v[200:201] op_sel:[1,1,0] op_sel_hi:[1,0,1] neg_lo:[1,0,0]
    v_pk_fma_f32 v[202:203], v[198:199], v[198:199], v[202:203] op_sel:[1,1,0] op_sel_hi:[1,0,1] neg_lo:[1,0,0]
    v_pk_fma_f32 v[140:141], v[136:137], v[194:195], v[140:141] op_sel:[1,1,0] op_sel_hi:[1,0,1] neg_lo:[1,0,0]
    v_pk_fma_f32 v[142:143], v[138:139], v[194:195], v[142:143] op_sel:[1,1,0] op_sel_hi:[1,0,1] neg_lo:[1,0,0]
    v_pk_fma_f32 v[92:93], v[76:77], v[88:89], v[92:93] op_sel:[1,1,0] op_sel_hi:[1,0,1] neg_lo:[1,0,0]
    v_pk_mul_f32 v[82:83], v[80:81], v[74:75] op_sel:[0,0] op_sel_hi:[0,1]
    v_pk_mul_f32 v[84:85], v[80:81], v[76:77] op_sel:[0,0] op_sel_hi:[0,1]
    v_pk_mul_f32 v[86:87], v[80:81], v[78:79] op_sel:[0,0] op_sel_hi:[0,1]
    v_pk_mul_f32 v[94:95], v[78:79], v[88:89] op_sel:[0,0] op_sel_hi:[0,1]
    v_pk_mul_f32 v[96:97], v[80:81], v[88:89] op_sel:[0,0] op_sel_hi:[0,1]
    v_pk_mul_f32 v[144:145], v[140:141], v[194:195] op_sel:[0,0] op_sel_hi:[0,1]
    v_pk_mul_f32 v[146:147], v[142:143], v[194:195] op_sel:[0,0] op_sel_hi:[0,1]
    v_pk_mul_f32 v[176:177], v[136:137], v[202:203] op_sel:[0,0] op_sel_hi:[0,1]
    v_pk_mul_f32 v[178:179], v[152:153], v[202:203] op_sel:[0,0] op_sel_hi:[0,1]
    v_pk_fma_f32 v[82:83], v[80:81], v[74:75], v[82:83] op_sel:[1,1,0] op_sel_hi:[1,0,1] neg_lo:[1,0,0]
    v_pk_fma_f32 v[84:85], v[80:81], v[76:77], v[84:85] op_sel:[1,1,0] op_sel_hi:[1,0,1] neg_lo:[1,0,0]
    v_pk_fma_f32 v[86:87], v[80:81], v[78:79], v[86:87] op_sel:[1,1,0] op_sel_hi:[1,0,1] neg_lo:[1,0,0]
    v_pk_fma_f32 v[94:95], v[78:79], v[88:89], v[94:95] op_sel:[1,1,0] op_sel_hi:[1,0,1] neg_lo:[1,0,0]
    v_pk_fma_f32 v[96:97], v[80:81], v[88:89], v[96:97] op_sel:[1,1,0] op_sel_hi:[1,0,1] neg_lo:[1,0,0]
    v_pk_fma_f32 v[144:145], v[140:141], v[194:195], v[144:145] op_sel:[1,1,0] op_sel_hi:[1,0,1] neg_lo:[1,0,0]
    v_pk_fma_f32 v[146:147], v[142:143], v[194:195], v[146:147] op_sel:[1,1,0] op_sel_hi:[1,0,1] neg_lo:[1,0,0]
    v_pk_fma_f32 v[176:177], v[136:137], v[202:203], v[176:177] op_sel:[1,1,0] op_sel_hi:[1,0,1] neg_lo:[1,0,0]
    v_pk_fma_f32 v[178:179], v[152:153], v[202:203], v[178:179] op_sel:[1,1,0] op_sel_hi:[1,0,1] neg_lo:[1,0,0]
    v_cvt_pk_bf16_f32 v204, v72, v73
    v_cvt_pk_bf16_f32 v205, v74, v75
    v_cvt_pk_bf16_f32 v206, v76, v77
    v_cvt_pk_bf16_f32 v207, v78, v79
    v_cvt_pk_bf16_f32 v208, v80, v81
    v_cvt_pk_bf16_f32 v209, v82, v83
    v_cvt_pk_bf16_f32 v210, v84, v85
    v_cvt_pk_bf16_f32 v211, v86, v87
    ds_write2_b32 v220, v204, v205 offset0:0 offset1:68
    ds_write2_b32 v220, v206, v207 offset0:136 offset1:204
    ds_write2_b32 v221, v208, v209 offset0:0 offset1:68
    ds_write2_b32 v221, v210, v211 offset0:136 offset1:204
    v_pk_mul_f32 v[98:99], v[82:83], v[88:89] op_sel:[0,0] op_sel_hi:[0,1]
    v_pk_mul_f32 v[100:101], v[84:85], v[88:89] op_sel:[0,0] op_sel_hi:[0,1]
    v_pk_mul_f32 v[102:103], v[86:87], v[88:89] op_sel:[0,0] op_sel_hi:[0,1]
    v_pk_mul_f32 v[106:107], v[74:75], v[104:105] op_sel:[0,0] op_sel_hi:[0,1]
    v_pk_mul_f32 v[108:109], v[76:77], v[104:105] op_sel:[0,0] op_sel_hi:[0,1]
    v_pk_mul_f32 v[110:111], v[78:79], v[104:105] op_sel:[0,0] op_sel_hi:[0,1]
    v_pk_mul_f32 v[112:113], v[80:81], v[104:105] op_sel:[0,0] op_sel_hi:[0,1]
    v_pk_mul_f32 v[114:115], v[82:83], v[104:105] op_sel:[0,0] op_sel_hi:[0,1]
    v_pk_fma_f32 v[98:99], v[82:83], v[88:89], v[98:99] op_sel:[1,1,0] op_sel_hi:[1,0,1] neg_lo:[1,0,0]
    v_pk_fma_f32 v[100:101], v[84:85], v[88:89], v[100:101] op_sel:[1,1,0] op_sel_hi:[1,0,1] neg_lo:[1,0,0]
    v_pk_fma_f32 v[102:103], v[86:87], v[88:89], v[102:103] op_sel:[1,1,0] op_sel_hi:[1,0,1] neg_lo:[1,0,0]
    v_pk_fma_f32 v[106:107], v[74:75], v[104:105], v[106:107] op_sel:[1,1,0] op_sel_hi:[1,0,1] neg_lo:[1,0,0]
    v_pk_fma_f32 v[108:109], v[76:77], v[104:105], v[108:109] op_sel:[1,1,0] op_sel_hi:[1,0,1] neg_lo:[1,0,0]
    v_pk_fma_f32 v[110:111], v[78:79], v[104:105], v[110:111] op_sel:[1,1,0] op_sel_hi:[1,0,1] neg_lo:[1,0,0]
    v_pk_fma_f32 v[112:113], v[80:81], v[104:105], v[112:113] op_sel:[1,1,0] op_sel_hi:[1,0,1] neg_lo:[1,0,0]
    v_pk_fma_f32 v[114:115], v[82:83], v[104:105], v[114:115] op_sel:[1,1,0] op_sel_hi:[1,0,1] neg_lo:[1,0,0]
    v_cvt_pk_bf16_f32 v204, v88, v89
    v_cvt_pk_bf16_f32 v205, v90, v91
    v_cvt_pk_bf16_f32 v206, v92, v93
    v_cvt_pk_bf16_f32 v207, v94, v95
    v_cvt_pk_bf16_f32 v208, v96, v97
    v_cvt_pk_bf16_f32 v209, v98, v99
    v_cvt_pk_bf16_f32 v210, v100, v101
    v_cvt_pk_bf16_f32 v211, v102, v103
    ds_write2_b32 v222, v204, v205 offset0:0 offset1:68
    ds_write2_b32 v222, v206, v207 offset0:136 offset1:204
    ds_write2_b32 v223, v208, v209 offset0:0 offset1:68
    ds_write2_b32 v223, v210, v211 offset0:136 offset1:204
    v_pk_mul_f32 v[116:117], v[84:85], v[104:105] op_sel:[0,0] op_sel_hi:[0,1]
    v_pk_mul_f32 v[118:119], v[86:87], v[104:105] op_sel:[0,0] op_sel_hi:[0,1]
    v_pk_mul_f32 v[122:123], v[74:75], v[120:121] op_sel:[0,0] op_sel_hi:[0,1]
    v_pk_mul_f32 v[124:125], v[76:77], v[120:121] op_sel:[0,0] op_sel_hi:[0,1]
    v_pk_mul_f32 v[126:127], v[78:79], v[120:121] op_sel:[0,0] op_sel_hi:[0,1]
    v_pk_mul_f32 v[128:129], v[80:81], v[120:121] op_sel:[0,0] op_sel_hi:[0,1]
    v_pk_mul_f32 v[130:131], v[82:83], v[120:121] op_sel:[0,0] op_sel_hi:[0,1]
    v_pk_mul_f32 v[132:133], v[84:85], v[120:121] op_sel:[0,0] op_sel_hi:[0,1]
    v_pk_mul_f32 v[134:135], v[86:87], v[120:121] op_sel:[0,0] op_sel_hi:[0,1]
    v_pk_fma_f32 v[116:117], v[84:85], v[104:105], v[116:117] op_sel:[1,1,0] op_sel_hi:[1,0,1] neg_lo:[1,0,0]
    v_pk_fma_f32 v[118:119], v[86:87], v[104:105], v[118:119] op_sel:[1,1,0] op_sel_hi:[1,0,1] neg_lo:[1,0,0]
    v_pk_fma_f32 v[122:123], v[74:75], v[120:121], v[122:123] op_sel:[1,1,0] op_sel_hi:[1,0,1] neg_lo:[1,0,0]
    v_pk_fma_f32 v[124:125], v[76:77], v[120:121], v[124:125] op_sel:[1,1,0] op_sel_hi:[1,0,1] neg_lo:[1,0,0]
    v_pk_fma_f32 v[126:127], v[78:79], v[120:121], v[126:127] op_sel:[1,1,0] op_sel_hi:[1,0,1] neg_lo:[1,0,0]
    v_pk_fma_f32 v[128:129], v[80:81], v[120:121], v[128:129] op_sel:[1,1,0] op_sel_hi:[1,0,1] neg_lo:[1,0,0]
    v_pk_fma_f32 v[130:131], v[82:83], v[120:121], v[130:131] op_sel:[1,1,0] op_sel_hi:[1,0,1] neg_lo:[1,0,0]
    v_pk_fma_f32 v[132:133], v[84:85], v[120:121], v[132:133] op_sel:[1,1,0] op_sel_hi:[1,0,1] neg_lo:[1,0,0]
    v_pk_fma_f32 v[134:135], v[86:87], v[120:121], v[134:135] op_sel:[1,1,0] op_sel_hi:[1,0,1] neg_lo:[1,0,0]
    v_cvt_pk_bf16_f32 v204, v104, v105
    v_cvt_pk_bf16_f32 v205, v106, v107
    v_cvt_pk_bf16_f32 v206, v108, v109
    v_cvt_pk_bf16_f32 v207, v110, v111
    v_cvt_pk_bf16_f32 v208, v112, v113
    v_cvt_pk_bf16_f32 v209, v114, v115
    v_cvt_pk_bf16_f32 v210, v116, v117
    v_cvt_pk_bf16_f32 v211, v118, v119
    ds_write2_b32 v224, v204, v205 offset0:0 offset1:68
    ds_write2_b32 v224, v206, v207 offset0:136 offset1:204
    ds_write2_b32 v225, v208, v209 offset0:0 offset1:68
    ds_write2_b32 v225, v210, v211 offset0:136 offset1:204
    v_pk_mul_f32 v[148:149], v[144:145], v[194:195] op_sel:[0,0] op_sel_hi:[0,1]
    v_pk_mul_f32 v[150:151], v[146:147], v[194:195] op_sel:[0,0] op_sel_hi:[0,1]
    v_pk_mul_f32 v[156:157], v[140:141], v[196:197] op_sel:[0,0] op_sel_hi:[0,1]
    v_pk_mul_f32 v[158:159], v[144:145], v[196:197] op_sel:[0,0] op_sel_hi:[0,1]
    v_pk_mul_f32 v[162:163], v[152:153], v[196:197] op_sel:[0,0] op_sel_hi:[0,1]
    v_pk_mul_f32 v[164:165], v[136:137], v[198:199] op_sel:[0,0] op_sel_hi:[0,1]
    v_pk_mul_f32 v[166:167], v[144:145], v[198:199] op_sel:[0,0] op_sel_hi:[0,1]
    v_pk_mul_f32 v[168:169], v[152:153], v[198:199] op_sel:[0,0] op_sel_hi:[0,1]
    v_pk_fma_f32 v[148:149], v[144:145], v[194:195], v[148:149] op_sel:[1,1,0] op_sel_hi:[1,0,1] neg_lo:[1,0,0]
    v_pk_fma_f32 v[150:151], v[146:147], v[194:195], v[150:151] op_sel:[1,1,0] op_sel_hi:[1,0,1] neg_lo:[1,0,0]
    v_pk_fma_f32 v[156:157], v[140:141], v[196:197], v[156:157] op_sel:[1,1,0] op_sel_hi:[1,0,1] neg_lo:[1,0,0]
    v_pk_fma_f32 v[158:159], v[144:145], v[196:197], v[158:159] op_sel:[1,1,0] op_sel_hi:[1,0,1] neg_lo:[1,0,0]
    v_pk_fma_f32 v[162:163], v[152:153], v[196:197], v[162:163] op_sel:[1,1,0] op_sel_hi:[1,0,1] neg_lo:[1,0,0]
    v_pk_fma_f32 v[164:165], v[136:137], v[198:199], v[164:165] op_sel:[1,1,0] op_sel_hi:[1,0,1] neg_lo:[1,0,0]
    v_pk_fma_f32 v[166:167], v[144:145], v[198:199], v[166:167] op_sel:[1,1,0] op_sel_hi:[1,0,1] neg_lo:[1,0,0]
    v_pk_fma_f32 v[168:169], v[152:153], v[198:199], v[168:169] op_sel:[1,1,0] op_sel_hi:[1,0,1] neg_lo:[1,0,0]
    v_cvt_pk_bf16_f32 v204, v120, v121
    v_cvt_pk_bf16_f32 v205, v122, v123
    v_cvt_pk_bf16_f32 v206, v124, v125
    v_cvt_pk_bf16_f32 v207, v126, v127
    v_cvt_pk_bf16_f32 v208, v128, v129
    v_cvt_pk_bf16_f32 v209, v130, v131
    v_cvt_pk_bf16_f32 v210, v132, v133
    v_cvt_pk_bf16_f32 v211, v134, v135
    ds_write2_b32 v226, v204, v205 offset0:0 offset1:68
    ds_write2_b32 v226, v206, v207 offset0:136 offset1:204
    ds_write2_b32 v227, v208, v209 offset0:0 offset1:68
    ds_write2_b32 v227, v210, v211 offset0:136 offset1:204
    ds_read_b128 v[40:43], v228 offset:0
    ds_read_b128 v[44:47], v228 offset:32
    ds_read_b128 v[48:51], v228 offset:64
    ds_read_b128 v[52:55], v228 offset:96
    ds_read_b128 v[56:59], v228 offset:128
    ds_read_b128 v[60:63], v228 offset:160
    ds_read_b128 v[64:67], v228 offset:192
    ds_read_b128 v[68:71], v228 offset:224
    v_pk_mul_f32 v[160:161], v[148:149], v[196:197] op_sel:[0,0] op_sel_hi:[0,1]
    v_pk_mul_f32 v[170:171], v[136:137], v[200:201] op_sel:[0,0] op_sel_hi:[0,1]
    v_pk_mul_f32 v[172:173], v[144:145], v[200:201] op_sel:[0,0] op_sel_hi:[0,1]
    v_pk_mul_f32 v[174:175], v[152:153], v[200:201] op_sel:[0,0] op_sel_hi:[0,1]
    v_pk_fma_f32 v[160:161], v[148:149], v[196:197], v[160:161] op_sel:[1,1,0] op_sel_hi:[1,0,1] neg_lo:[1,0,0]
    v_pk_fma_f32 v[170:171], v[136:137], v[200:201], v[170:171] op_sel:[1,1,0] op_sel_hi:[1,0,1] neg_lo:[1,0,0]
    v_pk_fma_f32 v[172:173], v[144:145], v[200:201], v[172:173] op_sel:[1,1,0] op_sel_hi:[1,0,1] neg_lo:[1,0,0]
    v_pk_fma_f32 v[174:175], v[152:153], v[200:201], v[174:175] op_sel:[1,1,0] op_sel_hi:[1,0,1] neg_lo:[1,0,0]
    v_cvt_pk_bf16_f32 v204, v136, -v137
    v_cvt_pk_bf16_f32 v205, v138, -v139
    v_cvt_pk_bf16_f32 v206, v140, -v141
    v_cvt_pk_bf16_f32 v207, v142, -v143
    v_cvt_pk_bf16_f32 v208, v154, -v155
    v_cvt_pk_bf16_f32 v209, v154, -v155
    v_cvt_pk_bf16_f32 v210, v156, -v157
    v_cvt_pk_bf16_f32 v211, v158, -v159
    ds_write2_b32 v220, v204, v205 offset0:0 offset1:68
    ds_write2_b32 v220, v206, v207 offset0:136 offset1:204
    ds_write2_b32 v221, v208, v209 offset0:0 offset1:68
    ds_write2_b32 v221, v210, v211 offset0:136 offset1:204
    v_pk_mul_f32 v[180:181], v[176:177], v[196:197] op_sel:[0,0] op_sel_hi:[0,1]
    v_pk_mul_f32 v[182:183], v[178:179], v[196:197] op_sel:[0,0] op_sel_hi:[0,1]
    v_pk_mul_f32 v[184:185], v[176:177], v[198:199] op_sel:[0,0] op_sel_hi:[0,1]
    v_pk_mul_f32 v[186:187], v[178:179], v[198:199] op_sel:[0,0] op_sel_hi:[0,1]
    v_pk_mul_f32 v[188:189], v[176:177], v[200:201] op_sel:[0,0] op_sel_hi:[0,1]
    v_pk_mul_f32 v[190:191], v[178:179], v[200:201] op_sel:[0,0] op_sel_hi:[0,1]
    v_pk_fma_f32 v[180:181], v[176:177], v[196:197], v[180:181] op_sel:[1,1,0] op_sel_hi:[1,0,1] neg_lo:[1,0,0]
    v_pk_fma_f32 v[182:183], v[178:179], v[196:197], v[182:183] op_sel:[1,1,0] op_sel_hi:[1,0,1] neg_lo:[1,0,0]
    v_pk_fma_f32 v[184:185], v[176:177], v[198:199], v[184:185] op_sel:[1,1,0] op_sel_hi:[1,0,1] neg_lo:[1,0,0]
    v_pk_fma_f32 v[186:187], v[178:179], v[198:199], v[186:187] op_sel:[1,1,0] op_sel_hi:[1,0,1] neg_lo:[1,0,0]
    v_pk_fma_f32 v[188:189], v[176:177], v[200:201], v[188:189] op_sel:[1,1,0] op_sel_hi:[1,0,1] neg_lo:[1,0,0]
    v_pk_fma_f32 v[190:191], v[178:179], v[200:201], v[190:191] op_sel:[1,1,0] op_sel_hi:[1,0,1] neg_lo:[1,0,0]
    v_cvt_pk_bf16_f32 v204, v144, -v145
    v_cvt_pk_bf16_f32 v205, v146, -v147
    v_cvt_pk_bf16_f32 v206, v148, -v149
    v_cvt_pk_bf16_f32 v207, v150, -v151
    v_cvt_pk_bf16_f32 v208, v158, -v159
    v_cvt_pk_bf16_f32 v209, v158, -v159
    v_cvt_pk_bf16_f32 v210, v160, -v161
    v_cvt_pk_bf16_f32 v211, v162, -v163
    ds_write2_b32 v222, v204, v205 offset0:0 offset1:68
    ds_write2_b32 v222, v206, v207 offset0:136 offset1:204
    ds_write2_b32 v223, v208, v209 offset0:0 offset1:68
    ds_write2_b32 v223, v210, v211 offset0:136 offset1:204
    v_cvt_pk_bf16_f32 v204, v152, -v153
    v_cvt_pk_bf16_f32 v205, v164, -v165
    v_cvt_pk_bf16_f32 v206, v166, -v167
    v_cvt_pk_bf16_f32 v207, v168, -v169
    v_cvt_pk_bf16_f32 v208, v162, -v163
    v_cvt_pk_bf16_f32 v209, v170, -v171
    v_cvt_pk_bf16_f32 v210, v172, -v173
    v_cvt_pk_bf16_f32 v211, v174, -v175
    ds_write2_b32 v224, v204, v205 offset0:0 offset1:68
    ds_write2_b32 v224, v206, v207 offset0:136 offset1:204
    ds_write2_b32 v225, v208, v209 offset0:0 offset1:68
    ds_write2_b32 v225, v210, v211 offset0:136 offset1:204
    v_cvt_pk_bf16_f32 v204, v176, -v177
    v_cvt_pk_bf16_f32 v205, v178, -v179
    v_cvt_pk_bf16_f32 v206, v184, -v185
    v_cvt_pk_bf16_f32 v207, v186, -v187
    v_cvt_pk_bf16_f32 v208, v180, -v181
    v_cvt_pk_bf16_f32 v209, v182, -v183
    v_cvt_pk_bf16_f32 v210, v188, -v189
    v_cvt_pk_bf16_f32 v211, v190, -v191
    ds_write2_b32 v226, v204, v205 offset0:0 offset1:68
    ds_write2_b32 v226, v206, v207 offset0:136 offset1:204
    ds_write2_b32 v227, v208, v209 offset0:0 offset1:68
    ds_write2_b32 v227, v210, v211 offset0:136 offset1:204
    ds_read_b128 v[72:75], v228 offset:0
    ds_read_b128 v[76:79], v228 offset:32
    ds_read_b128 v[80:83], v228 offset:64
    ds_read_b128 v[84:87], v228 offset:96
    ds_read_b128 v[88:91], v228 offset:128
    ds_read_b128 v[92:95], v228 offset:160
    ds_read_b128 v[96:99], v228 offset:192
    ds_read_b128 v[100:103], v228 offset:224
    s_waitcnt lgkmcnt(7)
    v_mfma_f32_32x32x16_bf16 v[24:39], v[72:75], v[40:43], 0
    s_waitcnt lgkmcnt(6)
    v_mfma_f32_32x32x16_bf16 v[24:39], v[76:79], v[44:47], v[24:39]
    s_waitcnt lgkmcnt(5)
    v_mfma_f32_32x32x16_bf16 v[24:39], v[80:83], v[48:51], v[24:39]
    s_waitcnt lgkmcnt(4)
    v_mfma_f32_32x32x16_bf16 v[24:39], v[84:87], v[52:55], v[24:39]
    s_waitcnt lgkmcnt(3)
    v_mfma_f32_32x32x16_bf16 v[24:39], v[88:91], v[56:59], v[24:39]
    s_waitcnt lgkmcnt(2)
    v_mfma_f32_32x32x16_bf16 v[24:39], v[92:95], v[60:63], v[24:39]
    s_waitcnt lgkmcnt(1)
    v_mfma_f32_32x32x16_bf16 v[24:39], v[96:99], v[64:67], v[24:39]
    s_waitcnt lgkmcnt(0)
    v_mfma_f32_32x32x16_bf16 v[24:39], v[100:103], v[68:71], v[24:39]
    s_lshl2_add_u32 s64, s15, 163432
    v_mov_b32 v16, s64
    v_mov_b32 v17, 1
    v_mov_b32 v12, 163104
    s_cmp_ge_u32 s3, 6
    s_cbranch_scc1 L_K2
    s_nop 5
    ds_write_b128 v22, v[24:27] offset:0
    ds_write_b128 v22, v[28:31] offset:1024
    ds_write_b128 v22, v[32:35] offset:2048
    ds_write_b128 v22, v[36:39] offset:3072
    ds_write_b32 v16, v17
    s_cmp_eq_u32 s3, 5
    s_cbranch_scc1 L_U3
    s_setprio 0
    s_cmp_eq_u32 s14, 0
    s_cbranch_scc1 L_conv1
    v_lshrrev_b32 v16, 4, v0
    v_bfe_u32 v17, v0, 2, 2
    v_xor_b32 v17, v17, v16
    v_lshlrev_b32 v17, 6, v17
    v_and_b32 v18, 3, v0
    v_lshl_add_u32 v17, v18, 4, v17
    s_lshl_b32 s64, s7, 8
    v_mul_u32_u24 v16, 3584, v16
    v_add3_u32 v40, v16, v17, s64
    v_add_u32 v41, 13312, v40
    v_add_u32 v42, 26624, v40
    v_add_u32 v43, 39936, v40
    s_mov_b32 s48, s36
    s_mov_b32 s49, s37
    s_mov_b32 s50, 0x1c0000
    s_mov_b32 s51, 0x20000
    s_add_u32 s64, s11, 2
    s_and_b32 s64, s64, 7
    s_mul_i32 s72, s64, 229376
    s_mov_b32 m0, 32768
    s_nop 0
    buffer_load_dwordx4 v40, s[48:51], s72 offen offset:0 lds
    buffer_load_dwordx4 v41, s[48:51], s72 offen offset:1024 lds
    buffer_load_dwordx4 v42, s[48:51], s72 offen offset:2048 lds
    buffer_load_dwordx4 v43, s[48:51], s72 offen offset:3072 lds
    s_mov_b32 m0, 36864
    s_add_u32 s72, s72, 57344
    buffer_load_dwordx4 v40, s[48:51], s72 offen offset:0 lds
    buffer_load_dwordx4 v41, s[48:51], s72 offen offset:1024 lds
    buffer_load_dwordx4 v42, s[48:51], s72 offen offset:2048 lds
    buffer_load_dwordx4 v43, s[48:51], s72 offen offset:3072 lds
    s_mov_b32 m0, 40960
    s_add_u32 s72, s72, 57344
    buffer_load_dwordx4 v40, s[48:51], s72 offen offset:0 lds
    buffer_load_dwordx4 v41, s[48:51], s72 offen offset:1024 lds
    buffer_load_dwordx4 v42, s[48:51], s72 offen offset:2048 lds
    buffer_load_dwordx4 v43, s[48:51], s72 offen offset:3072 lds
    s_mov_b32 m0, 45056
    s_add_u32 s72, s72, 57344
    buffer_load_dwordx4 v40, s[48:51], s72 offen offset:0 lds
    buffer_load_dwordx4 v41, s[48:51], s72 offen offset:1024 lds
    buffer_load_dwordx4 v42, s[48:51], s72 offen offset:2048 lds
    buffer_load_dwordx4 v43, s[48:51], s72 offen offset:3072 lds
    s_mov_b32 m0, 163136
    s_mov_b64 exec, 15
    buffer_load_dword off, s[60:63], 0 lds
    s_mov_b64 exec, -1
    s_add_u32 s64, s11, 3
    s_and_b32 s64, s64, 7
    s_mul_i32 s72, s64, 229376
    s_mov_b32 m0, 49152
    s_nop 0
    buffer_load_dwordx4 v40, s[48:51], s72 offen offset:0 lds
    buffer_load_dwordx4 v41, s[48:51], s72 offen offset:1024 lds
    buffer_load_dwordx4 v42, s[48:51], s72 offen offset:2048 lds
    buffer_load_dwordx4 v43, s[48:51], s72 offen offset:3072 lds
    s_mov_b32 m0, 53248
    s_add_u32 s72, s72, 57344
    buffer_load_dwordx4 v40, s[48:51], s72 offen offset:0 lds
    buffer_load_dwordx4 v41, s[48:51], s72 offen offset:1024 lds
    buffer_load_dwordx4 v42, s[48:51], s72 offen offset:2048 lds
    buffer_load_dwordx4 v43, s[48:51], s72 offen offset:3072 lds
    s_mov_b32 m0, 57344
    s_add_u32 s72, s72, 57344
    buffer_load_dwordx4 v40, s[48:51], s72 offen offset:0 lds
    buffer_load_dwordx4 v41, s[48:51], s72 offen offset:1024 lds
    buffer_load_dwordx4 v42, s[48:51], s72 offen offset:2048 lds
    buffer_load_dwordx4 v43, s[48:51], s72 offen offset:3072 lds
    s_mov_b32 m0, 61440
    s_add_u32 s72, s72, 57344
    buffer_load_dwordx4 v40, s[48:51], s72 offen offset:0 lds
    buffer_load_dwordx4 v41, s[48:51], s72 offen offset:1024 lds
    buffer_load_dwordx4 v42, s[48:51], s72 offen offset:2048 lds
    buffer_load_dwordx4 v43, s[48:51], s72 offen offset:3072 lds
    s_mov_b32 m0, 163152
    s_mov_b64 exec, 15
    buffer_load_dword off, s[60:63], 0 lds
    s_mov_b64 exec, -1
    s_add_u32 s64, s11, 4
    s_and_b32 s64, s64, 7
    s_mul_i32 s72, s64, 229376
    s_mov_b32 m0, 65536
    s_nop 0
    buffer_load_dwordx4 v40, s[48:51], s72 offen offset:0 lds
    buffer_load_dwordx4 v41, s[48:51], s72 offen offset:1024 lds
    buffer_load_dwordx4 v42, s[48:51], s72 offen offset:2048 lds
    buffer_load_dwordx4 v43, s[48:51], s72 offen offset:3072 lds
    s_mov_b32 m0, 69632
    s_add_u32 s72, s72, 57344
    buffer_load_dwordx4 v40, s[48:51], s72 offen offset:0 lds
    buffer_load_dwordx4 v41, s[48:51], s72 offen offset:1024 lds
    buffer_load_dwordx4 v42, s[48:51], s72 offen offset:2048 lds
    buffer_load_dwordx4 v43, s[48:51], s72 offen offset:3072 lds
    s_mov_b32 m0, 73728
    s_add_u32 s72, s72, 57344
    buffer_load_dwordx4 v40, s[48:51], s72 offen offset:0 lds
    buffer_load_dwordx4 v41, s[48:51], s72 offen offset:1024 lds
    buffer_load_dwordx4 v42, s[48:51], s72 offen offset:2048 lds
    buffer_load_dwordx4 v43, s[48:51], s72 offen offset:3072 lds
    s_mov_b32 m0, 77824
    s_add_u32 s72, s72, 57344
    buffer_load_dwordx4 v40, s[48:51], s72 offen offset:0 lds
    buffer_load_dwordx4 v41, s[48:51], s72 offen offset:1024 lds
    buffer_load_dwordx4 v42, s[48:51], s72 offen offset:2048 lds
    buffer_load_dwordx4 v43, s[48:51], s72 offen offset:3072 lds
    s_mov_b32 m0, 163168
    s_mov_b64 exec, 15
    buffer_load_dword off, s[60:63], 0 lds
    s_mov_b64 exec, -1
    s_add_u32 s64, s11, 5
    s_and_b32 s64, s64, 7
    s_mul_i32 s72, s64, 229376
    s_mov_b32 m0, 81920
    s_nop 0
    buffer_load_dwordx4 v40, s[48:51], s72 offen offset:0 lds
    buffer_load_dwordx4 v41, s[48:51], s72 offen offset:1024 lds
    buffer_load_dwordx4 v42, s[48:51], s72 offen offset:2048 lds
    buffer_load_dwordx4 v43, s[48:51], s72 offen offset:3072 lds
    s_mov_b32 m0, 86016
    s_add_u32 s72, s72, 57344
    buffer_load_dwordx4 v40, s[48:51], s72 offen offset:0 lds
    buffer_load_dwordx4 v41, s[48:51], s72 offen offset:1024 lds
    buffer_load_dwordx4 v42, s[48:51], s72 offen offset:2048 lds
    buffer_load_dwordx4 v43, s[48:51], s72 offen offset:3072 lds
    s_mov_b32 m0, 90112
    s_add_u32 s72, s72, 57344
    buffer_load_dwordx4 v40, s[48:51], s72 offen offset:0 lds
    buffer_load_dwordx4 v41, s[48:51], s72 offen offset:1024 lds
    buffer_load_dwordx4 v42, s[48:51], s72 offen offset:2048 lds
    buffer_load_dwordx4 v43, s[48:51], s72 offen offset:3072 lds
    s_mov_b32 m0, 94208
    s_add_u32 s72, s72, 57344
    buffer_load_dwordx4 v40, s[48:51], s72 offen offset:0 lds
    buffer_load_dwordx4 v41, s[48:51], s72 offen offset:1024 lds
    buffer_load_dwordx4 v42, s[48:51], s72 offen offset:2048 lds
    buffer_load_dwordx4 v43, s[48:51], s72 offen offset:3072 lds
    s_mov_b32 m0, 163184
    s_mov_b64 exec, 15
    buffer_load_dword off, s[60:63], 0 lds
    s_mov_b64 exec, -1
    s_add_u32 s64, s11, 6
    s_and_b32 s64, s64, 7
    s_mul_i32 s72, s64, 229376
    ds_read_b32 v16, v12 offset:336
    s_waitcnt lgkmcnt(0)
    v_readfirstlane_b32 s69, v16
    s_nop 0
    s_cmp_ge_u32 s69, 1
    s_cbranch_scc0 Lslow_46
Lret_47:
    s_mov_b32 m0, 98304
    s_nop 0
    buffer_load_dwordx4 v40, s[48:51], s72 offen offset:0 lds
    buffer_load_dwordx4 v41, s[48:51], s72 offen offset:1024 lds
    buffer_load_dwordx4 v42, s[48:51], s72 offen offset:2048 lds
    buffer_load_dwordx4 v43, s[48:51], s72 offen offset:3072 lds
    s_mov_b32 m0, 102400
    s_add_u32 s72, s72, 57344
    buffer_load_dwordx4 v40, s[48:51], s72 offen offset:0 lds
    buffer_load_dwordx4 v41, s[48:51], s72 offen offset:1024 lds
    buffer_load_dwordx4 v42, s[48:51], s72 offen offset:2048 lds
    buffer_load_dwordx4 v43, s[48:51], s72 offen offset:3072 lds
    s_mov_b32 m0, 106496
    s_add_u32 s72, s72, 57344
    buffer_load_dwordx4 v40, s[48:51], s72 offen offset:0 lds
    buffer_load_dwordx4 v41, s[48:51], s72 offen offset:1024 lds
    buffer_load_dwordx4 v42, s[48:51], s72 offen offset:2048 lds
    buffer_load_dwordx4 v43, s[48:51], s72 offen offset:3072 lds
    s_mov_b32 m0, 110592
    s_add_u32 s72, s72, 57344
    buffer_load_dwordx4 v40, s[48:51], s72 offen offset:0 lds
    buffer_load_dwordx4 v41, s[48:51], s72 offen offset:1024 lds
    buffer_load_dwordx4 v42, s[48:51], s72 offen offset:2048 lds
    buffer_load_dwordx4 v43, s[48:51], s72 offen offset:3072 lds
    s_mov_b32 m0, 163200
    s_mov_b64 exec, 15
    buffer_load_dword off, s[60:63], 0 lds
    s_mov_b64 exec, -1
    s_add_u32 s64, s11, 7
    s_and_b32 s64, s64, 7
    s_mul_i32 s72, s64, 229376
    ds_read_b64 v[16:17], v12 offset:320
    s_waitcnt lgkmcnt(0)
    v_min_u32 v20, v16, v17
    s_nop 0
    v_readfirstlane_b32 s69, v20
    s_nop 0
    s_cmp_ge_u32 s69, 1
    s_cbranch_scc0 Lslow_49
Lret_50:
    s_mov_b32 m0, 114688
    s_nop 0
    buffer_load_dwordx4 v40, s[48:51], s72 offen offset:0 lds
    buffer_load_dwordx4 v41, s[48:51], s72 offen offset:1024 lds
    buffer_load_dwordx4 v42, s[48:51], s72 offen offset:2048 lds
    buffer_load_dwordx4 v43, s[48:51], s72 offen offset:3072 lds
    s_mov_b32 m0, 118784
    s_add_u32 s72, s72, 57344
    buffer_load_dwordx4 v40, s[48:51], s72 offen offset:0 lds
    buffer_load_dwordx4 v41, s[48:51], s72 offen offset:1024 lds
    buffer_load_dwordx4 v42, s[48:51], s72 offen offset:2048 lds
    buffer_load_dwordx4 v43, s[48:51], s72 offen offset:3072 lds
    s_mov_b32 m0, 122880
    s_add_u32 s72, s72, 57344
    buffer_load_dwordx4 v40, s[48:51], s72 offen offset:0 lds
    buffer_load_dwordx4 v41, s[48:51], s72 offen offset:1024 lds
    buffer_load_dwordx4 v42, s[48:51], s72 offen offset:2048 lds
    buffer_load_dwordx4 v43, s[48:51], s72 offen offset:3072 lds
    s_mov_b32 m0, 126976
    s_add_u32 s72, s72, 57344
    buffer_load_dwordx4 v40, s[48:51], s72 offen offset:0 lds
    buffer_load_dwordx4 v41, s[48:51], s72 offen offset:1024 lds
    buffer_load_dwordx4 v42, s[48:51], s72 offen offset:2048 lds
    buffer_load_dwordx4 v43, s[48:51], s72 offen offset:3072 lds
    s_mov_b32 m0, 163216
    s_mov_b64 exec, 15
    buffer_load_dword off, s[60:63], 0 lds
    s_mov_b64 exec, -1
    v_lshrrev_b32 v16, 3, v0
    v_and_b32 v17, 7, v0
    v_bfe_u32 v18, v0, 4, 1
    v_lshlrev_b32 v18, 2, v18
    v_xor_b32 v17, v17, v18
    v_lshlrev_b32 v17, 4, v17
    v_lshl_add_u32 v17, v16, 10, v17
    s_lshl_b32 s64, s9, 7
    v_add_u32 v44, s64, v17
    v_add_u32 v45, 7168, v44
    v_add_u32 v46, 14336, v44
    v_add_u32 v47, 21504, v44
    s_mov_b32 s52, s38
    s_mov_b32 s53, s39
    s_mov_b32 s54, 0x1c0000
    s_mov_b32 s55, 0x20000
    ds_read_b128 v[16:19], v12 offset:128
    s_waitcnt lgkmcnt(0)
    v_or3_b32 v20, v16, v17, v18
    v_or_b32 v20, v20, v19
    s_nop 0
    v_readfirstlane_b32 s69, v20
    s_nop 0
    s_cmp_eq_u32 s69, 0
    s_cbranch_scc0 Lslow_52
Lret_53:
    s_add_u32 s64, s12, 0
    s_cmp_ge_u32 s64, 7
    s_cselect_b32 s65, 7, 0
    s_sub_u32 s64, s64, s65
    s_lshl_b32 s72, s64, 16
    s_mov_b32 m0, 0
    s_nop 0
    buffer_load_dwordx4 v44, s[52:55], s72 offen offset:0 lds
    buffer_load_dwordx4 v45, s[52:55], s72 offen offset:1024 lds
    buffer_load_dwordx4 v46, s[52:55], s72 offen offset:2048 lds
    buffer_load_dwordx4 v47, s[52:55], s72 offen offset:3072 lds
    s_mov_b32 m0, 4096
    s_add_u32 s72, s72, 32768
    buffer_load_dwordx4 v44, s[52:55], s72 offen offset:0 lds
    buffer_load_dwordx4 v45, s[52:55], s72 offen offset:1024 lds
    buffer_load_dwordx4 v46, s[52:55], s72 offen offset:2048 lds
    buffer_load_dwordx4 v47, s[52:55], s72 offen offset:3072 lds
    s_mov_b32 m0, 8192
    s_add_u32 s72, s72, 425984
    buffer_load_dwordx4 v44, s[52:55], s72 offen offset:0 lds
    buffer_load_dwordx4 v45, s[52:55], s72 offen offset:1024 lds
    buffer_load_dwordx4 v46, s[52:55], s72 offen offset:2048 lds
    buffer_load_dwordx4 v47, s[52:55], s72 offen offset:3072 lds
    s_mov_b32 m0, 12288
    s_add_u32 s72, s72, 32768
    buffer_load_dwordx4 v44, s[52:55], s72 offen offset:0 lds
    buffer_load_dwordx4 v45, s[52:55], s72 offen offset:1024 lds
    buffer_load_dwordx4 v46, s[52:55], s72 offen offset:2048 lds
    buffer_load_dwordx4 v47, s[52:55], s72 offen offset:3072 lds
    s_mov_b32 m0, 16384
    s_add_u32 s72, s72, 425984
    buffer_load_dwordx4 v44, s[52:55], s72 offen offset:0 lds
    buffer_load_dwordx4 v45, s[52:55], s72 offen offset:1024 lds
    buffer_load_dwordx4 v46, s[52:55], s72 offen offset:2048 lds
    buffer_load_dwordx4 v47, s[52:55], s72 offen offset:3072 lds
    s_mov_b32 m0, 20480
    s_add_u32 s72, s72, 32768
    buffer_load_dwordx4 v44, s[52:55], s72 offen offset:0 lds
    buffer_load_dwordx4 v45, s[52:55], s72 offen offset:1024 lds
    buffer_load_dwordx4 v46, s[52:55], s72 offen offset:2048 lds
    buffer_load_dwordx4 v47, s[52:55], s72 offen offset:3072 lds
    s_mov_b32 m0, 24576
    s_add_u32 s72, s72, 425984
    buffer_load_dwordx4 v44, s[52:55], s72 offen offset:0 lds
    buffer_load_dwordx4 v45, s[52:55], s72 offen offset:1024 lds
    buffer_load_dwordx4 v46, s[52:55], s72 offen offset:2048 lds
    buffer_load_dwordx4 v47, s[52:55], s72 offen offset:3072 lds
    s_mov_b32 m0, 28672
    s_add_u32 s72, s72, 32768
    buffer_load_dwordx4 v44, s[52:55], s72 offen offset:0 lds
    buffer_load_dwordx4 v45, s[52:55], s72 offen offset:1024 lds
    buffer_load_dwordx4 v46, s[52:55], s72 offen offset:2048 lds
    buffer_load_dwordx4 v47, s[52:55], s72 offen offset:3072 lds
    s_mov_b32 m0, 163360
    s_mov_b64 exec, 1
    buffer_load_dword off, s[60:63], 0 lds
    s_mov_b64 exec, -1
    ds_read_b128 v[16:19], v12 offset:144
    s_waitcnt lgkmcnt(0)
    v_or3_b32 v20, v16, v17, v18
    v_or_b32 v20, v20, v19
    s_nop 0
    v_readfirstlane_b32 s69, v20
    s_nop 0
    s_cmp_eq_u32 s69, 0
    s_cbranch_scc0 Lslow_55
Lret_56:
    s_add_u32 s64, s12, 1
    s_cmp_ge_u32 s64, 7
    s_cselect_b32 s65, 7, 0
    s_sub_u32 s64, s64, s65
    s_lshl_b32 s72, s64, 16
    s_mov_b32 m0, 32768
    s_nop 0
    buffer_load_dwordx4 v44, s[52:55], s72 offen offset:0 lds
    buffer_load_dwordx4 v45, s[52:55], s72 offen offset:1024 lds
    buffer_load_dwordx4 v46, s[52:55], s72 offen offset:2048 lds
    buffer_load_dwordx4 v47, s[52:55], s72 offen offset:3072 lds
    s_mov_b32 m0, 36864
    s_add_u32 s72, s72, 32768
    buffer_load_dwordx4 v44, s[52:55], s72 offen offset:0 lds
    buffer_load_dwordx4 v45, s[52:55], s72 offen offset:1024 lds
    buffer_load_dwordx4 v46, s[52:55], s72 offen offset:2048 lds
    buffer_load_dwordx4 v47, s[52:55], s72 offen offset:3072 lds
    s_mov_b32 m0, 40960
    s_add_u32 s72, s72, 425984
    buffer_load_dwordx4 v44, s[52:55], s72 offen offset:0 lds
    buffer_load_dwordx4 v45, s[52:55], s72 offen offset:1024 lds
    buffer_load_dwordx4 v46, s[52:55], s72 offen offset:2048 lds
    buffer_load_dwordx4 v47, s[52:55], s72 offen offset:3072 lds
    s_mov_b32 m0, 45056
    s_add_u32 s72, s72, 32768
    buffer_load_dwordx4 v44, s[52:55], s72 offen offset:0 lds
    buffer_load_dwordx4 v45, s[52:55], s72 offen offset:1024 lds
    buffer_load_dwordx4 v46, s[52:55], s72 offen offset:2048 lds
    buffer_load_dwordx4 v47, s[52:55], s72 offen offset:3072 lds
    s_mov_b32 m0, 49152
    s_add_u32 s72, s72, 425984
    buffer_load_dwordx4 v44, s[52:55], s72 offen offset:0 lds
    buffer_load_dwordx4 v45, s[52:55], s72 offen offset:1024 lds
    buffer_load_dwordx4 v46, s[52:55], s72 offen offset:2048 lds
    buffer_load_dwordx4 v47, s[52:55], s72 offen offset:3072 lds
    s_mov_b32 m0, 53248
    s_add_u32 s72, s72, 32768
    buffer_load_dwordx4 v44, s[52:55], s72 offen offset:0 lds
    buffer_load_dwordx4 v45, s[52:55], s72 offen offset:1024 lds
    buffer_load_dwordx4 v46, s[52:55], s72 offen offset:2048 lds
    buffer_load_dwordx4 v47, s[52:55], s72 offen offset:3072 lds
    s_mov_b32 m0, 57344
    s_add_u32 s72, s72, 425984
    buffer_load_dwordx4 v44, s[52:55], s72 offen offset:0 lds
    buffer_load_dwordx4 v45, s[52:55], s72 offen offset:1024 lds
    buffer_load_dwordx4 v46, s[52:55], s72 offen offset:2048 lds
    buffer_load_dwordx4 v47, s[52:55], s72 offen offset:3072 lds
    s_mov_b32 m0, 61440
    s_add_u32 s72, s72, 32768
    buffer_load_dwordx4 v44, s[52:55], s72 offen offset:0 lds
    buffer_load_dwordx4 v45, s[52:55], s72 offen offset:1024 lds
    buffer_load_dwordx4 v46, s[52:55], s72 offen offset:2048 lds
    buffer_load_dwordx4 v47, s[52:55], s72 offen offset:3072 lds
    s_mov_b32 m0, 163364
    s_mov_b64 exec, 1
    buffer_load_dword off, s[60:63], 0 lds
    s_mov_b64 exec, -1
    s_branch L_conv1
Lslow_46:
    s_mov_b32 s70, 524288
Lspin_48:
    ds_read_b32 v16, v12 offset:336
    s_waitcnt lgkmcnt(0)
    v_readfirstlane_b32 s69, v16
    s_nop 0
    s_cmp_ge_u32 s69, 1
    s_cbranch_scc1 Lret_47
    s_sleep 1
    s_sub_u32 s70, s70, 1
    s_cmp_lg_u32 s70, 0
    s_cbranch_scc1 Lspin_48
    s_branch Lret_47
Lslow_49:
    s_mov_b32 s70, 524288
Lspin_51:
    ds_read_b64 v[16:17], v12 offset:320
    s_waitcnt lgkmcnt(0)
    v_min_u32 v20, v16, v17
    s_nop 0
    v_readfirstlane_b32 s69, v20
    s_nop 0
    s_cmp_ge_u32 s69, 1
    s_cbranch_scc1 Lret_50
    s_sleep 1
    s_sub_u32 s70, s70, 1
    s_cmp_lg_u32 s70, 0
    s_cbranch_scc1 Lspin_51
    s_branch Lret_50
Lslow_52:
    s_mov_b32 s70, 524288
Lspin_54:
    ds_read_b128 v[16:19], v12 offset:128
    s_waitcnt lgkmcnt(0)
    v_or3_b32 v20, v16, v17, v18
    v_or_b32 v20, v20, v19
    s_nop 0
    v_readfirstlane_b32 s69, v20
    s_nop 0
    s_cmp_eq_u32 s69, 0
    s_cbranch_scc1 Lret_53
    s_sleep 1
    s_sub_u32 s70, s70, 1
    s_cmp_lg_u32 s70, 0
    s_cbranch_scc1 Lspin_54
    s_branch Lret_53
Lslow_55:
    s_mov_b32 s70, 524288
Lspin_57:
    ds_read_b128 v[16:19], v12 offset:144
    s_waitcnt lgkmcnt(0)
    v_or3_b32 v20, v16, v17, v18
    v_or_b32 v20, v20, v19
    s_nop 0
    v_readfirstlane_b32 s69, v20
    s_nop 0
    s_cmp_eq_u32 s69, 0
    s_cbranch_scc1 Lret_56
    s_sleep 1
    s_sub_u32 s70, s70, 1
    s_cmp_lg_u32 s70, 0
    s_cbranch_scc1 Lspin_57
    s_branch Lret_56
L_U3:
    v_mov_b32 v40, 0
    v_mov_b32 v41, 0
    v_mov_b32 v42, 0
    v_mov_b32 v43, 0
    v_min_u32 v19, 59, v0
    v_lshlrev_b32 v19, 4, v19
    v_add_u32 v19, 148480, v19
    ds_write_b128 v19, v[40:43]
    v_lshrrev_b32 v10, 3, v0
    v_lshlrev_b32 v14, 4, v0
    v_add_u32 v14, 98304, v14
    s_lshl_b32 s64, s9, 5
    s_add_u32 s64, s64, s8
    s_lshl2_add_u32 s68, s64, 8192
    s_lshl3_add_u32 s65, s8, s9
    s_lshl2_add_u32 s73, s65, 10240
    s_lshl_b32 s0, s65, 8
    s_add_u32 s0, s0, 65536
    v_lshlrev_b32 v64, 16, v252
    v_and_b32 v65, 0xffff0000, v252
    v_lshlrev_b32 v66, 16, v253
    v_and_b32 v67, 0xffff0000, v253
    v_lshlrev_b32 v68, 16, v254
    v_and_b32 v69, 0xffff0000, v254
    v_lshlrev_b32 v70, 16, v255
    v_and_b32 v71, 0xffff0000, v255
    v_mov_b32 v28, 0x3f803f80
    v_mov_b32 v100, 0
    v_mov_b32 v101, 0
    v_mov_b32 v102, 0
    v_mov_b32 v103, 0
    v_mov_b32 v104, 0
    v_mov_b32 v105, 0
    v_mov_b32 v106, 0
    v_mov_b32 v107, 0
    ds_read_b128 v[16:19], v12 offset:192
    s_waitcnt lgkmcnt(0)
    v_or3_b32 v20, v16, v17, v18
    v_or_b32 v20, v20, v19
    s_nop 0
    v_readfirstlane_b32 s69, v20
    s_nop 0
    s_cmp_eq_u32 s69, 0
    s_cbranch_scc0 Lslow_58
Lret_59:
    s_buffer_atomic_swap s13, s[56:59], s68
    s_add_u32 s69, s68, 8192
    s_buffer_atomic_swap s13, s[56:59], s69
    s_add_u32 s69, s68, 16384
    s_buffer_atomic_swap s13, s[56:59], s69
    s_add_u32 s69, s68, 24576
    s_buffer_atomic_swap s13, s[56:59], s69
    ds_read_b128 v[128:131], v14 offset:0
    ds_read_b128 v[132:135], v14 offset:1024
    ds_read_b128 v[136:139], v14 offset:4096
    ds_read_b128 v[140:143], v14 offset:5120
    ds_read_b128 v[144:147], v14 offset:8192
    ds_read_b128 v[148:151], v14 offset:9216
    ds_read_b128 v[152:155], v14 offset:12288
    ds_read_b128 v[156:159], v14 offset:13312
    v_mov_b32 v17, 1
    ds_write_b32 v12, v17 offset:336
    s_lshl_b32 s66, s4, 7
    s_add_u32 s66, s66, 8192
    v_and_b32 v18, 31, v0
    v_lshl_add_u32 v22, v18, 2, s66
    s_and_b32 s64, s5, 3
    s_lshl_b32 s64, s64, 13
    s_add_u32 s72, s66, s64
    s_lshl_b32 s64, s4, 18
    s_lshr_b32 s66, s5, 1
    s_lshl_b32 s66, s66, 7
    s_add_u32 s64, s64, s66
    s_and_b32 s66, s5, 1
    s_lshl_b32 s66, s66, 5
    s_add_u32 s64, s64, s66
    s_add_u32 s68, s64, 1048576
    v_lshrrev_b32 v25, 2, v0
    v_lshlrev_b32 v24, 11, v25
    v_bfe_u32 v26, v0, 1, 1
    v_lshl_add_u32 v24, v26, 6, v24
    v_add_u32 v25, 15, v25
    v_lshrrev_b32 v25, 2, v25
    v_xor_b32 v25, v25, v0
    v_and_b32 v25, 1, v25
    v_lshl_add_u32 v24, v25, 4, v24
    v_add_u32 v25, 31744, v24
    v_add_u32 v26, 63488, v24
    v_add_u32 v27, 95232, v24
    s_waitcnt lgkmcnt(0)
    s_setprio 0
    s_cmp_eq_u32 s14, 0
    s_cbranch_scc1 Lup_61
    ds_read_b128 v[16:19], v12 offset:128
    s_waitcnt lgkmcnt(0)
    v_or3_b32 v21, v16, v17, v18
    v_or_b32 v21, v21, v19
    s_nop 0
    v_readfirstlane_b32 s69, v21
    s_nop 0
    s_cmp_eq_u32 s69, 0
    s_cbranch_scc0 Lslow_62
Lret_63:
Lup_61:
    s_mov_b32 s66, s13
    s_mov_b32 s67, s13
    s_mov_b32 s70, 524288
Lsp_65:
    s_buffer_load_dwordx16 s[16:31], s[56:59], s72 glc
    s_waitcnt lgkmcnt(0)
    s_xor_b64 s[16:17], s[16:17], s[66:67]
    s_xor_b64 s[18:19], s[18:19], s[66:67]
    s_xor_b64 s[20:21], s[20:21], s[66:67]
    s_xor_b64 s[22:23], s[22:23], s[66:67]
    s_xor_b64 s[24:25], s[24:25], s[66:67]
    s_xor_b64 s[26:27], s[26:27], s[66:67]
    s_xor_b64 s[28:29], s[28:29], s[66:67]
    s_xor_b64 s[30:31], s[30:31], s[66:67]
    s_or_b64 s[16:17], s[16:17], s[18:19]
    s_or_b64 s[16:17], s[16:17], s[20:21]
    s_or_b64 s[16:17], s[16:17], s[22:23]
    s_or_b64 s[16:17], s[16:17], s[24:25]
    s_or_b64 s[16:17], s[16:17], s[26:27]
    s_or_b64 s[16:17], s[16:17], s[28:29]
    s_or_b64 s[16:17], s[16:17], s[30:31]
    s_cbranch_scc0 Lsd_66
    s_sleep 6
    s_sub_u32 s70, s70, 1
    s_cmp_lg_u32 s70, 0
    s_cbranch_scc1 Lsp_65
Lsd_66:
    s_add_u32 s72, s72, 64
    s_mov_b32 s66, s13
    s_mov_b32 s67, s13
    s_mov_b32 s70, 524288
Lsp_67:
    s_buffer_load_dwordx16 s[16:31], s[56:59], s72 glc
    s_waitcnt lgkmcnt(0)
    s_xor_b64 s[16:17], s[16:17], s[66:67]
    s_xor_b64 s[18:19], s[18:19], s[66:67]
    s_xor_b64 s[20:21], s[20:21], s[66:67]
    s_xor_b64 s[22:23], s[22:23], s[66:67]
    s_xor_b64 s[24:25], s[24:25], s[66:67]
    s_xor_b64 s[26:27], s[26:27], s[66:67]
    s_xor_b64 s[28:29], s[28:29], s[66:67]
    s_xor_b64 s[30:31], s[30:31], s[66:67]
    s_or_b64 s[16:17], s[16:17], s[18:19]
    s_or_b64 s[16:17], s[16:17], s[20:21]
    s_or_b64 s[16:17], s[16:17], s[22:23]
    s_or_b64 s[16:17], s[16:17], s[24:25]
    s_or_b64 s[16:17], s[16:17], s[26:27]
    s_or_b64 s[16:17], s[16:17], s[28:29]
    s_or_b64 s[16:17], s[16:17], s[30:31]
    s_cbranch_scc0 Lsd_68
    s_sleep 6
    s_sub_u32 s70, s70, 1
    s_cmp_lg_u32 s70, 0
    s_cbranch_scc1 Lsp_67
Lsd_68:
    s_setprio 3
    s_mov_b32 m0, 149440
    s_nop 0
    buffer_load_dwordx4 v24, s[56:59], s68 offen offset:0 sc1 lds
    buffer_load_dwordx4 v25, s[56:59], s68 offen offset:1024 sc1 lds
    buffer_load_dwordx4 v26, s[56:59], s68 offen offset:2048 sc1 lds
    buffer_load_dwordx4 v27, s[56:59], s68 offen offset:3072 sc1 lds
    s_mov_b32 m0, 153536
    s_add_u32 s68, s68, 131072
    buffer_load_dwordx4 v24, s[56:59], s68 offen offset:0 sc1 lds
    buffer_load_dwordx4 v25, s[56:59], s68 offen offset:1024 sc1 lds
    buffer_load_dwordx4 v26, s[56:59], s68 offen offset:2048 sc1 lds
    buffer_load_dwordx4 v27, s[56:59], s68 offen offset:3072 sc1 lds
    s_mov_b32 m0, 163328
    s_mov_b64 exec, 1
    buffer_load_dword off, s[60:63], 0 lds
    s_mov_b64 exec, -1
    s_setprio 0
    ds_read_b128 v[16:19], v12 offset:160
    s_waitcnt lgkmcnt(0)
    v_or3_b32 v21, v16, v17, v18
    v_or_b32 v21, v21, v19
    s_nop 0
    v_readfirstlane_b32 s69, v21
    s_nop 0
    s_cmp_eq_u32 s69, 0
    s_cbranch_scc0 Lslow_69
Lret_70:
    v_lshlrev_b32 v110, 16, v128
    v_and_b32 v111, 0xffff0000, v128
    v_lshlrev_b32 v112, 16, v129
    v_and_b32 v113, 0xffff0000, v129
    v_lshlrev_b32 v114, 16, v130
    v_and_b32 v115, 0xffff0000, v130
    v_lshlrev_b32 v116, 16, v131
    v_and_b32 v117, 0xffff0000, v131
    v_mul_f32 v110, v110, v64
    v_mul_f32 v111, v111, v65
    v_mul_f32 v112, v112, v66
    v_mul_f32 v113, v113, v67
    v_mul_f32 v114, v114, v68
    v_mul_f32 v115, v115, v69
    v_mul_f32 v116, v116, v70
    v_mul_f32 v117, v117, v71
    v_cvt_pk_bf16_f32 v110, v110, v111
    v_cvt_pk_bf16_f32 v112, v112, v113
    v_cvt_pk_bf16_f32 v114, v114, v115
    v_cvt_pk_bf16_f32 v116, v116, v117
    v_dot2c_f32_bf16 v100, v110, v28
    v_dot2c_f32_bf16 v100, v112, v28
    v_dot2c_f32_bf16 v100, v114, v28
    v_dot2c_f32_bf16 v100, v116, v28
    v_lshlrev_b32 v110, 16, v132
    v_and_b32 v111, 0xffff0000, v132
    v_lshlrev_b32 v112, 16, v133
    v_and_b32 v113, 0xffff0000, v133
    v_lshlrev_b32 v114, 16, v134
    v_and_b32 v115, 0xffff0000, v134
    v_lshlrev_b32 v116, 16, v135
    v_and_b32 v117, 0xffff0000, v135
    v_mul_f32 v110, v110, v64
    v_mul_f32 v111, v111, v65
    v_mul_f32 v112, v112, v66
    v_mul_f32 v113, v113, v67
    v_mul_f32 v114, v114, v68
    v_mul_f32 v115, v115, v69
    v_mul_f32 v116, v116, v70
    v_mul_f32 v117, v117, v71
    v_cvt_pk_bf16_f32 v110, v110, v111
    v_cvt_pk_bf16_f32 v112, v112, v113
    v_cvt_pk_bf16_f32 v114, v114, v115
    v_cvt_pk_bf16_f32 v116, v116, v117
    v_dot2c_f32_bf16 v101, v110, v28
    v_dot2c_f32_bf16 v101, v112, v28
    v_dot2c_f32_bf16 v101, v114, v28
    v_dot2c_f32_bf16 v101, v116, v28
    v_lshlrev_b32 v110, 16, v136
    v_and_b32 v111, 0xffff0000, v136
    v_lshlrev_b32 v112, 16, v137
    v_and_b32 v113, 0xffff0000, v137
    v_lshlrev_b32 v114, 16, v138
    v_and_b32 v115, 0xffff0000, v138
    v_lshlrev_b32 v116, 16, v139
    v_and_b32 v117, 0xffff0000, v139
    v_mul_f32 v110, v110, v64
    v_mul_f32 v111, v111, v65
    v_mul_f32 v112, v112, v66
    v_mul_f32 v113, v113, v67
    v_mul_f32 v114, v114, v68
    v_mul_f32 v115, v115, v69
    v_mul_f32 v116, v116, v70
    v_mul_f32 v117, v117, v71
    v_cvt_pk_bf16_f32 v110, v110, v111
    v_cvt_pk_bf16_f32 v112, v112, v113
    v_cvt_pk_bf16_f32 v114, v114, v115
    v_cvt_pk_bf16_f32 v116, v116, v117
    v_dot2c_f32_bf16 v102, v110, v28
    v_dot2c_f32_bf16 v102, v112, v28
    v_dot2c_f32_bf16 v102, v114, v28
    v_dot2c_f32_bf16 v102, v116, v28
    v_lshlrev_b32 v110, 16, v140
    v_and_b32 v111, 0xffff0000, v140
    v_lshlrev_b32 v112, 16, v141
    v_and_b32 v113, 0xffff0000, v141
    v_lshlrev_b32 v114, 16, v142
    v_and_b32 v115, 0xffff0000, v142
    v_lshlrev_b32 v116, 16, v143
    v_and_b32 v117, 0xffff0000, v143
    v_mul_f32 v110, v110, v64
    v_mul_f32 v111, v111, v65
    v_mul_f32 v112, v112, v66
    v_mul_f32 v113, v113, v67
    v_mul_f32 v114, v114, v68
    v_mul_f32 v115, v115, v69
    v_mul_f32 v116, v116, v70
    v_mul_f32 v117, v117, v71
    v_cvt_pk_bf16_f32 v110, v110, v111
    v_cvt_pk_bf16_f32 v112, v112, v113
    v_cvt_pk_bf16_f32 v114, v114, v115
    v_cvt_pk_bf16_f32 v116, v116, v117
    v_dot2c_f32_bf16 v103, v110, v28
    v_dot2c_f32_bf16 v103, v112, v28
    v_dot2c_f32_bf16 v103, v114, v28
    v_dot2c_f32_bf16 v103, v116, v28
    v_lshlrev_b32 v110, 16, v144
    v_and_b32 v111, 0xffff0000, v144
    v_lshlrev_b32 v112, 16, v145
    v_and_b32 v113, 0xffff0000, v145
    v_lshlrev_b32 v114, 16, v146
    v_and_b32 v115, 0xffff0000, v146
    v_lshlrev_b32 v116, 16, v147
    v_and_b32 v117, 0xffff0000, v147
    v_mul_f32 v110, v110, v64
    v_mul_f32 v111, v111, v65
    v_mul_f32 v112, v112, v66
    v_mul_f32 v113, v113, v67
    v_mul_f32 v114, v114, v68
    v_mul_f32 v115, v115, v69
    v_mul_f32 v116, v116, v70
    v_mul_f32 v117, v117, v71
    v_cvt_pk_bf16_f32 v110, v110, v111
    v_cvt_pk_bf16_f32 v112, v112, v113
    v_cvt_pk_bf16_f32 v114, v114, v115
    v_cvt_pk_bf16_f32 v116, v116, v117
    v_dot2c_f32_bf16 v104, v110, v28
    v_dot2c_f32_bf16 v104, v112, v28
    v_dot2c_f32_bf16 v104, v114, v28
    v_dot2c_f32_bf16 v104, v116, v28
    v_lshlrev_b32 v110, 16, v148
    v_and_b32 v111, 0xffff0000, v148
    v_lshlrev_b32 v112, 16, v149
    v_and_b32 v113, 0xffff0000, v149
    v_lshlrev_b32 v114, 16, v150
    v_and_b32 v115, 0xffff0000, v150
    v_lshlrev_b32 v116, 16, v151
    v_and_b32 v117, 0xffff0000, v151
    v_mul_f32 v110, v110, v64
    v_mul_f32 v111, v111, v65
    v_mul_f32 v112, v112, v66
    v_mul_f32 v113, v113, v67
    v_mul_f32 v114, v114, v68
    v_mul_f32 v115, v115, v69
    v_mul_f32 v116, v116, v70
    v_mul_f32 v117, v117, v71
    v_cvt_pk_bf16_f32 v110, v110, v111
    v_cvt_pk_bf16_f32 v112, v112, v113
    v_cvt_pk_bf16_f32 v114, v114, v115
    v_cvt_pk_bf16_f32 v116, v116, v117
    v_dot2c_f32_bf16 v105, v110, v28
    v_dot2c_f32_bf16 v105, v112, v28
    v_dot2c_f32_bf16 v105, v114, v28
    v_dot2c_f32_bf16 v105, v116, v28
    v_lshlrev_b32 v110, 16, v152
    v_and_b32 v111, 0xffff0000, v152
    v_lshlrev_b32 v112, 16, v153
    v_and_b32 v113, 0xffff0000, v153
    v_lshlrev_b32 v114, 16, v154
    v_and_b32 v115, 0xffff0000, v154
    v_lshlrev_b32 v116, 16, v155
    v_and_b32 v117, 0xffff0000, v155
    v_mul_f32 v110, v110, v64
    v_mul_f32 v111, v111, v65
    v_mul_f32 v112, v112, v66
    v_mul_f32 v113, v113, v67
    v_mul_f32 v114, v114, v68
    v_mul_f32 v115, v115, v69
    v_mul_f32 v116, v116, v70
    v_mul_f32 v117, v117, v71
    v_cvt_pk_bf16_f32 v110, v110, v111
    v_cvt_pk_bf16_f32 v112, v112, v113
    v_cvt_pk_bf16_f32 v114, v114, v115
    v_cvt_pk_bf16_f32 v116, v116, v117
    v_dot2c_f32_bf16 v106, v110, v28
    v_dot2c_f32_bf16 v106, v112, v28
    v_dot2c_f32_bf16 v106, v114, v28
    v_dot2c_f32_bf16 v106, v116, v28
    v_lshlrev_b32 v110, 16, v156
    v_and_b32 v111, 0xffff0000, v156
    v_lshlrev_b32 v112, 16, v157
    v_and_b32 v113, 0xffff0000, v157
    v_lshlrev_b32 v114, 16, v158
    v_and_b32 v115, 0xffff0000, v158
    v_lshlrev_b32 v116, 16, v159
    v_and_b32 v117, 0xffff0000, v159
    v_mul_f32 v110, v110, v64
    v_mul_f32 v111, v111, v65
    v_mul_f32 v112, v112, v66
    v_mul_f32 v113, v113, v67
    v_mul_f32 v114, v114, v68
    v_mul_f32 v115, v115, v69
    v_mul_f32 v116, v116, v70
    v_mul_f32 v117, v117, v71
    v_cvt_pk_bf16_f32 v110, v110, v111
    v_cvt_pk_bf16_f32 v112, v112, v113
    v_cvt_pk_bf16_f32 v114, v114, v115
    v_cvt_pk_bf16_f32 v116, v116, v117
    v_dot2c_f32_bf16 v107, v110, v28
    v_dot2c_f32_bf16 v107, v112, v28
    v_dot2c_f32_bf16 v107, v114, v28
    v_dot2c_f32_bf16 v107, v116, v28
    v_add_f32_dpp v100, v100, v100 quad_perm:[1,0,3,2] row_mask:0xf bank_mask:0xf
    v_add_f32_dpp v101, v101, v101 quad_perm:[1,0,3,2] row_mask:0xf bank_mask:0xf
    v_add_f32_dpp v102, v102, v102 quad_perm:[1,0,3,2] row_mask:0xf bank_mask:0xf
    v_add_f32_dpp v103, v103, v103 quad_perm:[1,0,3,2] row_mask:0xf bank_mask:0xf
    v_add_f32_dpp v104, v104, v104 quad_perm:[1,0,3,2] row_mask:0xf bank_mask:0xf
    v_add_f32_dpp v105, v105, v105 quad_perm:[1,0,3,2] row_mask:0xf bank_mask:0xf
    v_add_f32_dpp v106, v106, v106 quad_perm:[1,0,3,2] row_mask:0xf bank_mask:0xf
    v_add_f32_dpp v107, v107, v107 quad_perm:[1,0,3,2] row_mask:0xf bank_mask:0xf
    v_add_f32_dpp v100, v100, v100 quad_perm:[2,3,0,1] row_mask:0xf bank_mask:0xf
    v_add_f32_dpp v101, v101, v101 quad_perm:[2,3,0,1] row_mask:0xf bank_mask:0xf
    v_add_f32_dpp v102, v102, v102 quad_perm:[2,3,0,1] row_mask:0xf bank_mask:0xf
    v_add_f32_dpp v103, v103, v103 quad_perm:[2,3,0,1] row_mask:0xf bank_mask:0xf
    v_add_f32_dpp v104, v104, v104 quad_perm:[2,3,0,1] row_mask:0xf bank_mask:0xf
    v_add_f32_dpp v105, v105, v105 quad_perm:[2,3,0,1] row_mask:0xf bank_mask:0xf
    v_add_f32_dpp v106, v106, v106 quad_perm:[2,3,0,1] row_mask:0xf bank_mask:0xf
    v_add_f32_dpp v107, v107, v107 quad_perm:[2,3,0,1] row_mask:0xf bank_mask:0xf
    v_add_f32_dpp v100, v100, v100 row_half_mirror row_mask:0xf bank_mask:0xf
    v_add_f32_dpp v101, v101, v101 row_half_mirror row_mask:0xf bank_mask:0xf
    v_add_f32_dpp v102, v102, v102 row_half_mirror row_mask:0xf bank_mask:0xf
    v_add_f32_dpp v103, v103, v103 row_half_mirror row_mask:0xf bank_mask:0xf
    v_add_f32_dpp v104, v104, v104 row_half_mirror row_mask:0xf bank_mask:0xf
    v_add_f32_dpp v105, v105, v105 row_half_mirror row_mask:0xf bank_mask:0xf
    v_add_f32_dpp v106, v106, v106 row_half_mirror row_mask:0xf bank_mask:0xf
    v_add_f32_dpp v107, v107, v107 row_half_mirror row_mask:0xf bank_mask:0xf
    v_cmp_eq_u32 vcc, 1, v11
    s_nop 1
    v_cndmask_b32 v100, v100, v101, vcc
    v_cmp_eq_u32 vcc, 2, v11
    s_nop 1
    v_cndmask_b32 v100, v100, v102, vcc
    v_cmp_eq_u32 vcc, 3, v11
    s_nop 1
    v_cndmask_b32 v100, v100, v103, vcc
    v_cmp_eq_u32 vcc, 4, v11
    s_nop 1
    v_cndmask_b32 v100, v100, v104, vcc
    v_cmp_eq_u32 vcc, 5, v11
    s_nop 1
    v_cndmask_b32 v100, v100, v105, vcc
    v_cmp_eq_u32 vcc, 6, v11
    s_nop 1
    v_cndmask_b32 v100, v100, v106, vcc
    v_cmp_eq_u32 vcc, 7, v11
    s_nop 1
    v_cndmask_b32 v100, v100, v107, vcc
    v_lshl_add_u32 v10, v11, 3, v10
    v_lshlrev_b32 v10, 2, v10
    v_mov_b32 v11, v100
L_conv1:
    s_mul_i32 s65, s15, 8704
    s_add_u32 s65, s65, 134174
    v_and_b32 v18, 15, v0
    v_lshrrev_b32 v19, 4, v0
    v_add_u32 v16, -1, v18
    v_or_b32 v16, 1, v16
    v_lshlrev_b32 v16, 1, v16
    v_lshlrev_b32 v17, 4, v19
    v_sub_u32 v17, v17, v16
    v_and_b32 v16, 1, v18
    v_xor_b32 v16, 1, v16
    v_mul_u32_u24 v16, 4160, v16
    v_add3_u32 v2, v17, v16, s65
    v_subrev_u32 v3, 1024, v2
    v_subrev_u32 v4, 2048, v2
    v_subrev_u32 v5, 3072, v2
    v_lshrrev_b32 v20, 1, v19
    v_and_b32 v21, 1, v19
    v_add_u32 v16, v18, v20
    v_lshlrev_b32 v17, 6, v16
    v_lshl_add_u32 v17, v21, 5, v17
    v_add_u32 v17, 148480, v17
    v_add_u32 v6, 0, v16
    v_bfe_u32 v6, v6, 2, 1
    v_xor_b32 v6, s15, v6
    v_lshl_add_u32 v168, v6, 4, v17
    v_xor_b32 v170, 16, v168
    v_add_u32 v6, 2, v16
    v_bfe_u32 v6, v6, 2, 1
    v_xor_b32 v6, s15, v6
    v_lshl_add_u32 v169, v6, 4, v17
    v_xor_b32 v171, 16, v169
    v_add_u32 v16, 15, v18
    v_lshlrev_b32 v17, 6, v16
    v_lshl_add_u32 v17, v20, 5, v17
    v_lshl_add_u32 v17, v21, 3, v17
    v_bfe_u32 v6, v16, 2, 1
    v_xor_b32 v6, s15, v6
    v_lshl_add_u32 v17, v6, 4, v17
    v_add_u32 v7, 148480, v17
    v_lshrrev_b32 v16, 2, v18
    v_lshlrev_b32 v16, 7, v16
    v_and_b32 v17, 3, v18
    v_lshl_add_u32 v16, v17, 4, v16
    v_lshrrev_b32 v17, 1, v19
    v_lshl_add_u32 v16, v17, 6, v16
    v_and_b32 v17, 1, v19
    v_lshl_add_u32 v8, v17, 9, v16
    s_lshl_b32 s1, s71, 12
    s_add_u32 s1, s1, 3145728
    s_lshl2_add_u32 s6, s71, 14336
    v_lshlrev_b32 v13, 16, v13
    s_lshl2_add_u32 s64, s15, 163424
    v_mov_b32 v20, s64
    ds_read_b32 v16, v20 offset:0
    s_waitcnt lgkmcnt(0)
    v_readfirstlane_b32 s69, v16
    s_nop 0
    s_cmp_ge_u32 s69, 1
    s_cbranch_scc0 Lslow_72
Lret_73:
    s_setprio 0
    ds_read_b128 v[16:19], v12 offset:160
    s_waitcnt lgkmcnt(0)
    v_or3_b32 v21, v16, v17, v18
    v_or_b32 v21, v21, v19
    s_nop 0
    v_readfirstlane_b32 s69, v21
    s_nop 0
    s_cmp_eq_u32 s69, 0
    s_cbranch_scc0 Lslow_75
Lret_76:
    ds_read_b32 v16, v12 offset:224
    s_waitcnt lgkmcnt(0)
    v_readfirstlane_b32 s69, v16
    s_nop 0
    s_cmp_eq_u32 s69, 0
    s_cbranch_scc0 Lslow_78
Lret_79:
    ds_read2_b32 v[40:41], v2 offset0:240 offset1:241
    ds_read2_b32 v[42:43], v2 offset0:242 offset1:243
    ds_read_b128 v[72:75], v171 offset:896
    ds_read2_b32 v[44:45], v2 offset0:112 offset1:113
    ds_read2_b32 v[46:47], v2 offset0:114 offset1:115
    ds_read_b128 v[76:79], v171 offset:1920
    ds_read2_b32 v[48:49], v3 offset0:240 offset1:241
    ds_read2_b32 v[50:51], v3 offset0:242 offset1:243
    ds_read_b128 v[80:83], v171 offset:2944
    ds_read2_b32 v[52:53], v3 offset0:112 offset1:113
    ds_read2_b32 v[54:55], v3 offset0:114 offset1:115
    ds_read_b128 v[84:87], v171 offset:3968
    ds_read2_b32 v[56:57], v4 offset0:240 offset1:241
    ds_read2_b32 v[58:59], v4 offset0:242 offset1:243
    ds_read_b128 v[88:91], v171 offset:4992
    ds_read2_b32 v[60:61], v4 offset0:112 offset1:113
    ds_read2_b32 v[62:63], v4 offset0:114 offset1:115
    ds_read_b128 v[92:95], v171 offset:6016
    ds_read2_b32 v[64:65], v5 offset0:240 offset1:241
    ds_read2_b32 v[66:67], v5 offset0:242 offset1:243
    ds_read_b128 v[96:99], v171 offset:7040
    ds_read2_b32 v[68:69], v5 offset0:112 offset1:113
    ds_read2_b32 v[70:71], v5 offset0:114 offset1:115
    ds_read_b128 v[100:103], v171 offset:8064
    s_waitcnt lgkmcnt(13)
    s_waitcnt lgkmcnt(12)
    v_mfma_f32_16x16x32_bf16 v[16:19], v[52:55], v[84:87], 0
    ds_read2_b32 v[104:105], v2 offset0:224 offset1:225
    ds_read2_b32 v[106:107], v2 offset0:226 offset1:227
    s_waitcnt lgkmcnt(11)
    v_mfma_f32_16x16x32_bf16 v[16:19], v[48:51], v[88:91], v[16:19]
    ds_read_b128 v[136:139], v170 offset:768
    ds_read2_b32 v[108:109], v2 offset0:96 offset1:97
    v_mfma_f32_16x16x32_bf16 v[16:19], v[56:59], v[80:83], v[16:19]
    ds_read2_b32 v[110:111], v2 offset0:98 offset1:99
    ds_read_b128 v[140:143], v170 offset:1792
    v_mfma_f32_16x16x32_bf16 v[20:23], v[52:55], v[88:91], 0
    ds_read2_b32 v[112:113], v3 offset0:224 offset1:225
    ds_read2_b32 v[114:115], v3 offset0:226 offset1:227
    v_mfma_f32_16x16x32_bf16 v[20:23], v[56:59], v[84:87], v[20:23]
    ds_read_b128 v[144:147], v170 offset:2816
    ds_read2_b32 v[116:117], v3 offset0:96 offset1:97
    s_waitcnt lgkmcnt(15)
    v_mfma_f32_16x16x32_bf16 v[16:19], v[44:47], v[92:95], v[16:19]
    ds_read2_b32 v[118:119], v3 offset0:98 offset1:99
    ds_read_b128 v[148:151], v170 offset:3840
    v_mfma_f32_16x16x32_bf16 v[16:19], v[60:63], v[76:79], v[16:19]
    ds_read2_b32 v[120:121], v4 offset0:224 offset1:225
    ds_read2_b32 v[122:123], v4 offset0:226 offset1:227
    v_mfma_f32_16x16x32_bf16 v[20:23], v[48:51], v[92:95], v[20:23]
    ds_read_b128 v[152:155], v170 offset:4864
    ds_read2_b32 v[124:125], v4 offset0:96 offset1:97
    v_mfma_f32_16x16x32_bf16 v[20:23], v[60:63], v[80:83], v[20:23]
    ds_read2_b32 v[126:127], v4 offset0:98 offset1:99
    ds_read_b128 v[156:159], v170 offset:5888
    s_waitcnt lgkmcnt(15)
    v_mfma_f32_16x16x32_bf16 v[16:19], v[40:43], v[96:99], v[16:19]
    ds_read2_b32 v[128:129], v5 offset0:224 offset1:225
    ds_read2_b32 v[130:131], v5 offset0:226 offset1:227
    v_mfma_f32_16x16x32_bf16 v[16:19], v[64:67], v[72:75], v[16:19]
    ds_read_b128 v[160:163], v170 offset:6912
    ds_read2_b32 v[132:133], v5 offset0:96 offset1:97
    v_mfma_f32_16x16x32_bf16 v[20:23], v[44:47], v[96:99], v[20:23]
    ds_read2_b32 v[134:135], v5 offset0:98 offset1:99
    ds_read_b128 v[164:167], v170 offset:7936
    v_mfma_f32_16x16x32_bf16 v[20:23], v[64:67], v[76:79], v[20:23]
    v_mfma_f32_16x16x32_bf16 v[20:23], v[40:43], v[100:103], v[20:23]
    v_mfma_f32_16x16x32_bf16 v[20:23], v[68:71], v[72:75], v[20:23]
    s_waitcnt lgkmcnt(13)
    s_waitcnt lgkmcnt(12)
    v_mfma_f32_16x16x32_bf16 v[16:19], v[116:119], v[148:151], v[16:19]
    ds_read2_b32 v[40:41], v2 offset0:208 offset1:209
    ds_read2_b32 v[42:43], v2 offset0:210 offset1:211
    s_waitcnt lgkmcnt(11)
    v_mfma_f32_16x16x32_bf16 v[16:19], v[112:115], v[152:155], v[16:19]
    ds_read_b128 v[72:75], v169 offset:640
    ds_read2_b32 v[44:45], v2 offset0:80 offset1:81
    v_mfma_f32_16x16x32_bf16 v[16:19], v[120:123], v[144:147], v[16:19]
    ds_read2_b32 v[46:47], v2 offset0:82 offset1:83
    ds_read_b128 v[76:79], v169 offset:1664
    v_mfma_f32_16x16x32_bf16 v[20:23], v[116:119], v[152:155], v[20:23]
    ds_read2_b32 v[48:49], v3 offset0:208 offset1:209
    ds_read2_b32 v[50:51], v3 offset0:210 offset1:211
    v_mfma_f32_16x16x32_bf16 v[20:23], v[120:123], v[148:151], v[20:23]
    ds_read_b128 v[80:83], v169 offset:2688
    ds_read2_b32 v[52:53], v3 offset0:80 offset1:81
    s_waitcnt lgkmcnt(15)
    v_mfma_f32_16x16x32_bf16 v[16:19], v[108:111], v[156:159], v[16:19]
    ds_read2_b32 v[54:55], v3 offset0:82 offset1:83
    ds_read_b128 v[84:87], v169 offset:3712
    v_mfma_f32_16x16x32_bf16 v[16:19], v[124:127], v[140:143], v[16:19]
    ds_read2_b32 v[56:57], v4 offset0:208 offset1:209
    ds_read2_b32 v[58:59], v4 offset0:210 offset1:211
    v_mfma_f32_16x16x32_bf16 v[20:23], v[112:115], v[156:159], v[20:23]
    ds_read_b128 v[88:91], v169 offset:4736
    ds_read2_b32 v[60:61], v4 offset0:80 offset1:81
    v_mfma_f32_16x16x32_bf16 v[20:23], v[124:127], v[144:147], v[20:23]
    ds_read2_b32 v[62:63], v4 offset0:82 offset1:83
    ds_read_b128 v[92:95], v169 offset:5760
    s_waitcnt lgkmcnt(15)
    v_mfma_f32_16x16x32_bf16 v[16:19], v[104:107], v[160:163], v[16:19]
    ds_read2_b32 v[64:65], v5 offset0:208 offset1:209
    ds_read2_b32 v[66:67], v5 offset0:210 offset1:211
    v_mfma_f32_16x16x32_bf16 v[16:19], v[128:131], v[136:139], v[16:19]
    ds_read_b128 v[96:99], v169 offset:6784
    ds_read2_b32 v[68:69], v5 offset0:80 offset1:81
    v_mfma_f32_16x16x32_bf16 v[20:23], v[108:111], v[160:163], v[20:23]
    ds_read2_b32 v[70:71], v5 offset0:82 offset1:83
    ds_read_b128 v[100:103], v169 offset:7808
    v_mfma_f32_16x16x32_bf16 v[20:23], v[128:131], v[140:143], v[20:23]
    v_mfma_f32_16x16x32_bf16 v[20:23], v[104:107], v[164:167], v[20:23]
    v_mfma_f32_16x16x32_bf16 v[20:23], v[132:135], v[136:139], v[20:23]
    s_waitcnt lgkmcnt(13)
    s_waitcnt lgkmcnt(12)
    v_mfma_f32_16x16x32_bf16 v[16:19], v[52:55], v[84:87], v[16:19]
    ds_read2_b32 v[104:105], v2 offset0:192 offset1:193
    ds_read2_b32 v[106:107], v2 offset0:194 offset1:195
    s_waitcnt lgkmcnt(11)
    v_mfma_f32_16x16x32_bf16 v[16:19], v[48:51], v[88:91], v[16:19]
    ds_read_b128 v[136:139], v168 offset:512
    ds_read2_b32 v[108:109], v2 offset0:64 offset1:65
    v_mfma_f32_16x16x32_bf16 v[16:19], v[56:59], v[80:83], v[16:19]
    ds_read2_b32 v[110:111], v2 offset0:66 offset1:67
    ds_read_b128 v[140:143], v168 offset:1536
    v_mfma_f32_16x16x32_bf16 v[20:23], v[52:55], v[88:91], v[20:23]
    ds_read2_b32 v[112:113], v3 offset0:192 offset1:193
    ds_read2_b32 v[114:115], v3 offset0:194 offset1:195
    v_mfma_f32_16x16x32_bf16 v[20:23], v[56:59], v[84:87], v[20:23]
    ds_read_b128 v[144:147], v168 offset:2560
    ds_read2_b32 v[116:117], v3 offset0:64 offset1:65
    s_waitcnt lgkmcnt(15)
    v_mfma_f32_16x16x32_bf16 v[16:19], v[44:47], v[92:95], v[16:19]
    ds_read2_b32 v[118:119], v3 offset0:66 offset1:67
    ds_read_b128 v[148:151], v168 offset:3584
    v_mfma_f32_16x16x32_bf16 v[16:19], v[60:63], v[76:79], v[16:19]
    ds_read2_b32 v[120:121], v4 offset0:192 offset1:193
    ds_read2_b32 v[122:123], v4 offset0:194 offset1:195
    v_mfma_f32_16x16x32_bf16 v[20:23], v[48:51], v[92:95], v[20:23]
    ds_read_b128 v[152:155], v168 offset:4608
    ds_read2_b32 v[124:125], v4 offset0:64 offset1:65
    v_mfma_f32_16x16x32_bf16 v[20:23], v[60:63], v[80:83], v[20:23]
    ds_read2_b32 v[126:127], v4 offset0:66 offset1:67
    ds_read_b128 v[156:159], v168 offset:5632
    s_waitcnt lgkmcnt(15)
    v_mfma_f32_16x16x32_bf16 v[16:19], v[40:43], v[96:99], v[16:19]
    ds_read2_b32 v[128:129], v5 offset0:192 offset1:193
    ds_read2_b32 v[130:131], v5 offset0:194 offset1:195
    v_mfma_f32_16x16x32_bf16 v[16:19], v[64:67], v[72:75], v[16:19]
    ds_read_b128 v[160:163], v168 offset:6656
    ds_read2_b32 v[132:133], v5 offset0:64 offset1:65
    v_mfma_f32_16x16x32_bf16 v[20:23], v[44:47], v[96:99], v[20:23]
    ds_read2_b32 v[134:135], v5 offset0:66 offset1:67
    ds_read_b128 v[164:167], v168 offset:7680
    v_mfma_f32_16x16x32_bf16 v[20:23], v[64:67], v[76:79], v[20:23]
    v_mfma_f32_16x16x32_bf16 v[20:23], v[40:43], v[100:103], v[20:23]
    v_mfma_f32_16x16x32_bf16 v[20:23], v[68:71], v[72:75], v[20:23]
    s_waitcnt lgkmcnt(13)
    s_waitcnt lgkmcnt(12)
    v_mfma_f32_16x16x32_bf16 v[16:19], v[116:119], v[148:151], v[16:19]
    ds_read2_b32 v[40:41], v2 offset0:176 offset1:177
    ds_read2_b32 v[42:43], v2 offset0:178 offset1:179
    s_waitcnt lgkmcnt(11)
    v_mfma_f32_16x16x32_bf16 v[16:19], v[112:115], v[152:155], v[16:19]
    ds_read_b128 v[72:75], v171 offset:384
    ds_read2_b32 v[44:45], v2 offset0:48 offset1:49
    v_mfma_f32_16x16x32_bf16 v[16:19], v[120:123], v[144:147], v[16:19]
    ds_read2_b32 v[46:47], v2 offset0:50 offset1:51
    ds_read_b128 v[76:79], v171 offset:1408
    v_mfma_f32_16x16x32_bf16 v[20:23], v[116:119], v[152:155], v[20:23]
    ds_read2_b32 v[48:49], v3 offset0:176 offset1:177
    ds_read2_b32 v[50:51], v3 offset0:178 offset1:179
    v_mfma_f32_16x16x32_bf16 v[20:23], v[120:123], v[148:151], v[20:23]
    ds_read_b128 v[80:83], v171 offset:2432
    ds_read2_b32 v[52:53], v3 offset0:48 offset1:49
    s_waitcnt lgkmcnt(15)
    v_mfma_f32_16x16x32_bf16 v[16:19], v[108:111], v[156:159], v[16:19]
    ds_read2_b32 v[54:55], v3 offset0:50 offset1:51
    ds_read_b128 v[84:87], v171 offset:3456
    v_mfma_f32_16x16x32_bf16 v[16:19], v[124:127], v[140:143], v[16:19]
    ds_read2_b32 v[56:57], v4 offset0:176 offset1:177
    ds_read2_b32 v[58:59], v4 offset0:178 offset1:179
    v_mfma_f32_16x16x32_bf16 v[20:23], v[112:115], v[156:159], v[20:23]
    ds_read_b128 v[88:91], v171 offset:4480
    ds_read2_b32 v[60:61], v4 offset0:48 offset1:49
    v_mfma_f32_16x16x32_bf16 v[20:23], v[124:127], v[144:147], v[20:23]
    ds_read2_b32 v[62:63], v4 offset0:50 offset1:51
    ds_read_b128 v[92:95], v171 offset:5504
    s_waitcnt lgkmcnt(15)
    v_mfma_f32_16x16x32_bf16 v[16:19], v[104:107], v[160:163], v[16:19]
    ds_read2_b32 v[64:65], v5 offset0:176 offset1:177
    ds_read2_b32 v[66:67], v5 offset0:178 offset1:179
    v_mfma_f32_16x16x32_bf16 v[16:19], v[128:131], v[136:139], v[16:19]
    ds_read_b128 v[96:99], v171 offset:6528
    ds_read2_b32 v[68:69], v5 offset0:48 offset1:49
    v_mfma_f32_16x16x32_bf16 v[20:23], v[108:111], v[160:163], v[20:23]
    ds_read2_b32 v[70:71], v5 offset0:50 offset1:51
    ds_read_b128 v[100:103], v171 offset:7552
    v_mfma_f32_16x16x32_bf16 v[20:23], v[128:131], v[140:143], v[20:23]
    v_mfma_f32_16x16x32_bf16 v[20:23], v[104:107], v[164:167], v[20:23]
    v_mfma_f32_16x16x32_bf16 v[20:23], v[132:135], v[136:139], v[20:23]
    s_waitcnt lgkmcnt(13)
    s_waitcnt lgkmcnt(12)
    v_mfma_f32_16x16x32_bf16 v[16:19], v[52:55], v[84:87], v[16:19]
    ds_read2_b32 v[104:105], v2 offset0:160 offset1:161
    ds_read2_b32 v[106:107], v2 offset0:162 offset1:163
    s_waitcnt lgkmcnt(11)
    v_mfma_f32_16x16x32_bf16 v[16:19], v[48:51], v[88:91], v[16:19]
    ds_read_b128 v[136:139], v170 offset:256
    ds_read2_b32 v[108:109], v2 offset0:32 offset1:33
    v_mfma_f32_16x16x32_bf16 v[16:19], v[56:59], v[80:83], v[16:19]
    ds_read2_b32 v[110:111], v2 offset0:34 offset1:35
    ds_read_b128 v[140:143], v170 offset:1280
    v_mfma_f32_16x16x32_bf16 v[20:23], v[52:55], v[88:91], v[20:23]
    ds_read2_b32 v[112:113], v3 offset0:160 offset1:161
    ds_read2_b32 v[114:115], v3 offset0:162 offset1:163
    v_mfma_f32_16x16x32_bf16 v[20:23], v[56:59], v[84:87], v[20:23]
    ds_read_b128 v[144:147], v170 offset:2304
    ds_read2_b32 v[116:117], v3 offset0:32 offset1:33
    s_waitcnt lgkmcnt(15)
    v_mfma_f32_16x16x32_bf16 v[16:19], v[44:47], v[92:95], v[16:19]
    ds_read2_b32 v[118:119], v3 offset0:34 offset1:35
    ds_read_b128 v[148:151], v170 offset:3328
    v_mfma_f32_16x16x32_bf16 v[16:19], v[60:63], v[76:79], v[16:19]
    ds_read2_b32 v[120:121], v4 offset0:160 offset1:161
    ds_read2_b32 v[122:123], v4 offset0:162 offset1:163
    v_mfma_f32_16x16x32_bf16 v[20:23], v[48:51], v[92:95], v[20:23]
    ds_read_b128 v[152:155], v170 offset:4352
    ds_read2_b32 v[124:125], v4 offset0:32 offset1:33
    v_mfma_f32_16x16x32_bf16 v[20:23], v[60:63], v[80:83], v[20:23]
    ds_read2_b32 v[126:127], v4 offset0:34 offset1:35
    ds_read_b128 v[156:159], v170 offset:5376
    s_waitcnt lgkmcnt(15)
    v_mfma_f32_16x16x32_bf16 v[16:19], v[40:43], v[96:99], v[16:19]
    ds_read2_b32 v[128:129], v5 offset0:160 offset1:161
    ds_read2_b32 v[130:131], v5 offset0:162 offset1:163
    v_mfma_f32_16x16x32_bf16 v[16:19], v[64:67], v[72:75], v[16:19]
    ds_read_b128 v[160:163], v170 offset:6400
    ds_read2_b32 v[132:133], v5 offset0:32 offset1:33
    v_mfma_f32_16x16x32_bf16 v[20:23], v[44:47], v[96:99], v[20:23]
    ds_read2_b32 v[134:135], v5 offset0:34 offset1:35
    ds_read_b128 v[164:167], v170 offset:7424
    v_mfma_f32_16x16x32_bf16 v[20:23], v[64:67], v[76:79], v[20:23]
    v_mfma_f32_16x16x32_bf16 v[20:23], v[40:43], v[100:103], v[20:23]
    v_mfma_f32_16x16x32_bf16 v[20:23], v[68:71], v[72:75], v[20:23]
    s_waitcnt lgkmcnt(13)
    s_waitcnt lgkmcnt(12)
    v_mfma_f32_16x16x32_bf16 v[16:19], v[116:119], v[148:151], v[16:19]
    ds_read2_b32 v[40:41], v2 offset0:144 offset1:145
    ds_read2_b32 v[42:43], v2 offset0:146 offset1:147
    s_waitcnt lgkmcnt(11)
    v_mfma_f32_16x16x32_bf16 v[16:19], v[112:115], v[152:155], v[16:19]
    ds_read_b128 v[72:75], v169 offset:128
    ds_read2_b32 v[44:45], v2 offset0:16 offset1:17
    v_mfma_f32_16x16x32_bf16 v[16:19], v[120:123], v[144:147], v[16:19]
    ds_read2_b32 v[46:47], v2 offset0:18 offset1:19
    ds_read_b128 v[76:79], v169 offset:1152
    v_mfma_f32_16x16x32_bf16 v[20:23], v[116:119], v[152:155], v[20:23]
    ds_read2_b32 v[48:49], v3 offset0:144 offset1:145
    ds_read2_b32 v[50:51], v3 offset0:146 offset1:147
    v_mfma_f32_16x16x32_bf16 v[20:23], v[120:123], v[148:151], v[20:23]
    ds_read_b128 v[80:83], v169 offset:2176
    ds_read2_b32 v[52:53], v3 offset0:16 offset1:17
    s_waitcnt lgkmcnt(15)
    v_mfma_f32_16x16x32_bf16 v[16:19], v[108:111], v[156:159], v[16:19]
    ds_read2_b32 v[54:55], v3 offset0:18 offset1:19
    ds_read_b128 v[84:87], v169 offset:3200
    v_mfma_f32_16x16x32_bf16 v[16:19], v[124:127], v[140:143], v[16:19]
    ds_read2_b32 v[56:57], v4 offset0:144 offset1:145
    ds_read2_b32 v[58:59], v4 offset0:146 offset1:147
    v_mfma_f32_16x16x32_bf16 v[20:23], v[112:115], v[156:159], v[20:23]
    ds_read_b128 v[88:91], v169 offset:4224
    ds_read2_b32 v[60:61], v4 offset0:16 offset1:17
    v_mfma_f32_16x16x32_bf16 v[20:23], v[124:127], v[144:147], v[20:23]
    ds_read2_b32 v[62:63], v4 offset0:18 offset1:19
    ds_read_b128 v[92:95], v169 offset:5248
    s_waitcnt lgkmcnt(15)
    v_mfma_f32_16x16x32_bf16 v[16:19], v[104:107], v[160:163], v[16:19]
    ds_read2_b32 v[64:65], v5 offset0:144 offset1:145
    ds_read2_b32 v[66:67], v5 offset0:146 offset1:147
    v_mfma_f32_16x16x32_bf16 v[16:19], v[128:131], v[136:139], v[16:19]
    ds_read_b128 v[96:99], v169 offset:6272
    ds_read2_b32 v[68:69], v5 offset0:16 offset1:17
    v_mfma_f32_16x16x32_bf16 v[20:23], v[108:111], v[160:163], v[20:23]
    ds_read2_b32 v[70:71], v5 offset0:18 offset1:19
    ds_read_b128 v[100:103], v169 offset:7296
    v_mfma_f32_16x16x32_bf16 v[20:23], v[128:131], v[140:143], v[20:23]
    v_mfma_f32_16x16x32_bf16 v[20:23], v[104:107], v[164:167], v[20:23]
    v_mfma_f32_16x16x32_bf16 v[20:23], v[132:135], v[136:139], v[20:23]
    s_waitcnt lgkmcnt(13)
    s_waitcnt lgkmcnt(12)
    v_mfma_f32_16x16x32_bf16 v[16:19], v[52:55], v[84:87], v[16:19]
    ds_read2_b32 v[104:105], v2 offset0:128 offset1:129
    ds_read2_b32 v[106:107], v2 offset0:130 offset1:131
    s_waitcnt lgkmcnt(11)
    v_mfma_f32_16x16x32_bf16 v[16:19], v[48:51], v[88:91], v[16:19]
    ds_read_b128 v[136:139], v168 offset:0
    ds_read2_b32 v[108:109], v2 offset0:0 offset1:1
    v_mfma_f32_16x16x32_bf16 v[16:19], v[56:59], v[80:83], v[16:19]
    ds_read2_b32 v[110:111], v2 offset0:2 offset1:3
    ds_read_b128 v[140:143], v168 offset:1024
    v_mfma_f32_16x16x32_bf16 v[20:23], v[52:55], v[88:91], v[20:23]
    ds_read2_b32 v[112:113], v3 offset0:128 offset1:129
    ds_read2_b32 v[114:115], v3 offset0:130 offset1:131
    v_mfma_f32_16x16x32_bf16 v[20:23], v[56:59], v[84:87], v[20:23]
    ds_read_b128 v[144:147], v168 offset:2048
    ds_read2_b32 v[116:117], v3 offset0:0 offset1:1
    s_waitcnt lgkmcnt(15)
    v_mfma_f32_16x16x32_bf16 v[16:19], v[44:47], v[92:95], v[16:19]
    ds_read2_b32 v[118:119], v3 offset0:2 offset1:3
    ds_read_b128 v[148:151], v168 offset:3072
    v_mfma_f32_16x16x32_bf16 v[16:19], v[60:63], v[76:79], v[16:19]
    ds_read2_b32 v[120:121], v4 offset0:128 offset1:129
    ds_read2_b32 v[122:123], v4 offset0:130 offset1:131
    v_mfma_f32_16x16x32_bf16 v[20:23], v[48:51], v[92:95], v[20:23]
    ds_read_b128 v[152:155], v168 offset:4096
    ds_read2_b32 v[124:125], v4 offset0:0 offset1:1
    v_mfma_f32_16x16x32_bf16 v[20:23], v[60:63], v[80:83], v[20:23]
    ds_read2_b32 v[126:127], v4 offset0:2 offset1:3
    ds_read_b128 v[156:159], v168 offset:5120
    s_waitcnt lgkmcnt(15)
    v_mfma_f32_16x16x32_bf16 v[16:19], v[40:43], v[96:99], v[16:19]
    ds_read2_b32 v[128:129], v5 offset0:128 offset1:129
    ds_read2_b32 v[130:131], v5 offset0:130 offset1:131
    v_mfma_f32_16x16x32_bf16 v[16:19], v[64:67], v[72:75], v[16:19]
    ds_read_b128 v[160:163], v168 offset:6144
    ds_read2_b32 v[132:133], v5 offset0:0 offset1:1
    v_mfma_f32_16x16x32_bf16 v[20:23], v[44:47], v[96:99], v[20:23]
    ds_read2_b32 v[134:135], v5 offset0:2 offset1:3
    ds_read_b128 v[164:167], v168 offset:7168
    v_mfma_f32_16x16x32_bf16 v[20:23], v[64:67], v[76:79], v[20:23]
    v_mfma_f32_16x16x32_bf16 v[20:23], v[40:43], v[100:103], v[20:23]
    v_mfma_f32_16x16x32_bf16 v[20:23], v[68:71], v[72:75], v[20:23]
    s_waitcnt lgkmcnt(13)
    s_waitcnt lgkmcnt(12)
    v_mfma_f32_16x16x32_bf16 v[16:19], v[116:119], v[148:151], v[16:19]
    ds_read_b64 v[176:177], v7 offset:6144
    s_waitcnt lgkmcnt(10)
    v_mfma_f32_16x16x32_bf16 v[16:19], v[112:115], v[152:155], v[16:19]
    ds_read_b64 v[178:179], v7 offset:7168
    v_mfma_f32_16x16x32_bf16 v[16:19], v[120:123], v[144:147], v[16:19]
    v_mfma_f32_16x16x32_bf16 v[20:23], v[116:119], v[152:155], v[20:23]
    v_mfma_f32_16x16x32_bf16 v[20:23], v[120:123], v[148:151], v[20:23]
    s_waitcnt lgkmcnt(8)
    v_mfma_f32_16x16x32_bf16 v[16:19], v[108:111], v[156:159], v[16:19]
    v_mfma_f32_16x16x32_bf16 v[16:19], v[124:127], v[140:143], v[16:19]
    v_mfma_f32_16x16x32_bf16 v[20:23], v[112:115], v[156:159], v[20:23]
    v_mfma_f32_16x16x32_bf16 v[20:23], v[124:127], v[144:147], v[20:23]
    s_waitcnt lgkmcnt(5)
    v_mfma_f32_16x16x32_bf16 v[16:19], v[104:107], v[160:163], v[16:19]
    v_mfma_f32_16x16x32_bf16 v[16:19], v[128:131], v[136:139], v[16:19]
    v_mfma_f32_16x16x32_bf16 v[20:23], v[108:111], v[160:163], v[20:23]
    v_mfma_f32_16x16x32_bf16 v[20:23], v[128:131], v[140:143], v[20:23]
    s_waitcnt lgkmcnt(2)
    v_mfma_f32_16x16x32_bf16 v[20:23], v[104:107], v[164:167], v[20:23]
    v_mfma_f32_16x16x32_bf16 v[20:23], v[132:135], v[136:139], v[20:23]
    s_waitcnt lgkmcnt(0)
    s_setprio 2
    v_lshlrev_b32 v68, 16, v176
    v_and_b32 v69, 0xffff0000, v176
    v_lshlrev_b32 v70, 16, v177
    v_and_b32 v71, 0xffff0000, v177
    v_lshlrev_b32 v72, 16, v178
    v_and_b32 v73, 0xffff0000, v178
    v_lshlrev_b32 v74, 16, v179
    v_and_b32 v75, 0xffff0000, v179
    v_mul_f32 v68, v13, v68
    v_mul_f32 v69, v13, v69
    v_mul_f32 v70, v13, v70
    v_mul_f32 v71, v13, v71
    v_mul_f32 v72, v13, v72
    v_mul_f32 v73, v13, v73
    v_mul_f32 v74, v13, v74
    v_mul_f32 v75, v13, v75
    v_cvt_pk_bf16_f32 v84, v16, v17
    v_cvt_pk_bf16_f32 v85, v18, v19
    v_cvt_pk_bf16_f32 v86, v20, v21
    v_cvt_pk_bf16_f32 v87, v22, v23
    v_cvt_pk_bf16_f32 v88, v68, v69
    v_lshlrev_b32 v76, 16, v84
    v_and_b32 v77, 0xffff0000, v84
    v_cvt_pk_bf16_f32 v89, v70, v71
    v_lshlrev_b32 v78, 16, v85
    v_and_b32 v79, 0xffff0000, v85
    v_cvt_pk_bf16_f32 v90, v72, v73
    v_lshlrev_b32 v80, 16, v86
    v_and_b32 v81, 0xffff0000, v86
    v_cvt_pk_bf16_f32 v91, v74, v75
    v_lshlrev_b32 v82, 16, v87
    v_and_b32 v83, 0xffff0000, v87
    v_lshlrev_b32 v68, 16, v88
    v_and_b32 v69, 0xffff0000, v88
    v_lshlrev_b32 v70, 16, v89
    v_and_b32 v71, 0xffff0000, v89
    v_lshlrev_b32 v72, 16, v90
    v_and_b32 v73, 0xffff0000, v90
    v_lshlrev_b32 v74, 16, v91
    v_and_b32 v75, 0xffff0000, v91
    v_add_f32 v68, v68, v76
    v_add_f32 v69, v69, v77
    v_add_f32 v70, v70, v78
    v_add_f32 v71, v71, v79
    v_add_f32 v72, v72, v80
    v_add_f32 v73, v73, v81
    v_add_f32 v74, v74, v82
    v_add_f32 v75, v75, v83
    v_cvt_pk_bf16_f32 v56, v68, v69
    v_cvt_pk_bf16_f32 v57, v70, v71
    v_cvt_pk_bf16_f32 v58, v72, v73
    v_cvt_pk_bf16_f32 v59, v74, v75
    s_nop 0
    v_permlane16_swap_b32 v56, v58
    v_permlane16_swap_b32 v57, v59
    buffer_store_dwordx4 v[56:59], v8, s[56:59], s1 offen offset:3072 sc1
    s_cmp_lg_u32 s3, 5
    s_cbranch_scc1 L_ngs
    buffer_store_dword v11, v10, s[56:59], s0 offen sc1
L_ngs:
    s_lshl2_add_u32 m0, s3, 163296
    s_mov_b64 exec, 1
    buffer_load_dword off, s[60:63], 0 lds
    s_mov_b64 exec, -1
    v_and_b32 v242, 7, v0
    v_lshrrev_b32 v240, 3, v0
    v_lshlrev_b32 v241, 1, v242
    v_xor_b32 v241, v241, v240
    v_lshlrev_b32 v241, 4, v241
    v_lshl_add_u32 v241, v240, 8, v241
    s_and_b32 s64, s3, 3
    s_lshl_b32 s64, s64, 11
    s_cmp_lt_u32 s3, 4
    s_cselect_b32 s65, 98304, 0
    s_add_u32 s64, s64, s65
    v_add_u32 v232, s64, v241
    v_xor_b32 v233, 16, v232
    v_xor_b32 v241, v242, v240
    v_lshlrev_b32 v241, 4, v241
    v_lshl_add_u32 v241, v240, 7, v241
    s_lshl_b32 s64, s3, 10
    s_add_u32 s64, s64, 148480
    v_add_u32 v234, s64, v241
    s_lshl_b32 s64, s3, 5
    s_add_u32 s64, s64, 163456
    v_lshl_add_u32 v235, v240, 2, s64
    v_lshlrev_b32 v241, 4, v242
    v_lshl_add_u32 v236, v240, 10, v241
    s_lshl3_add_u32 s64, s8, s3
    s_lshl_b32 s64, s64, 13
    s_lshl_b32 s65, s9, 7
    s_add_u32 s64, s64, s65
    v_add_u32 v236, s64, v236
    s_waitcnt vmcnt(1)
    s_buffer_atomic_swap s13, s[56:59], s6
    s_add_u32 s69, s6, 8192
    s_buffer_atomic_swap s13, s[56:59], s69
    s_add_u32 s69, s6, 16384
    s_buffer_atomic_swap s13, s[56:59], s69
    s_add_u32 s69, s6, 24576
    s_buffer_atomic_swap s13, s[56:59], s69
    s_cmp_lg_u32 s3, 5
    s_cbranch_scc1 L_ngf
    s_buffer_atomic_swap s13, s[56:59], s73
    s_add_u32 s69, s73, 8192
    s_buffer_atomic_swap s13, s[56:59], s69
    s_add_u32 s69, s73, 16384
    s_buffer_atomic_swap s13, s[56:59], s69
    s_add_u32 s69, s73, 24576
    s_buffer_atomic_swap s13, s[56:59], s69
L_ngf:
    s_branch L_late
Lslow_58:
    s_mov_b32 s70, 524288
Lspin_60:
    ds_read_b128 v[16:19], v12 offset:192
    s_waitcnt lgkmcnt(0)
    v_or3_b32 v20, v16, v17, v18
    v_or_b32 v20, v20, v19
    s_nop 0
    v_readfirstlane_b32 s69, v20
    s_nop 0
    s_cmp_eq_u32 s69, 0
    s_cbranch_scc1 Lret_59
    s_sleep 1
    s_sub_u32 s70, s70, 1
    s_cmp_lg_u32 s70, 0
    s_cbranch_scc1 Lspin_60
    s_branch Lret_59
Lslow_62:
    s_mov_b32 s70, 524288
Lspin_64:
    ds_read_b128 v[16:19], v12 offset:128
    s_waitcnt lgkmcnt(0)
    v_or3_b32 v21, v16, v17, v18
    v_or_b32 v21, v21, v19
    s_nop 0
    v_readfirstlane_b32 s69, v21
    s_nop 0
    s_cmp_eq_u32 s69, 0
    s_cbranch_scc1 Lret_63
    s_sleep 2
    s_sub_u32 s70, s70, 1
    s_cmp_lg_u32 s70, 0
    s_cbranch_scc1 Lspin_64
    s_branch Lret_63
Lslow_69:
    s_mov_b32 s70, 524288
Lspin_71:
    ds_read_b128 v[16:19], v12 offset:160
    s_waitcnt lgkmcnt(0)
    v_or3_b32 v21, v16, v17, v18
    v_or_b32 v21, v21, v19
    s_nop 0
    v_readfirstlane_b32 s69, v21
    s_nop 0
    s_cmp_eq_u32 s69, 0
    s_cbranch_scc1 Lret_70
    s_sleep 2
    s_sub_u32 s70, s70, 1
    s_cmp_lg_u32 s70, 0
    s_cbranch_scc1 Lspin_71
    s_branch Lret_70
Lslow_72:
    s_mov_b32 s70, 524288
Lspin_74:
    ds_read_b32 v16, v20 offset:0
    s_waitcnt lgkmcnt(0)
    v_readfirstlane_b32 s69, v16
    s_nop 0
    s_cmp_ge_u32 s69, 1
    s_cbranch_scc1 Lret_73
    s_sleep 1
    s_sub_u32 s70, s70, 1
    s_cmp_lg_u32 s70, 0
    s_cbranch_scc1 Lspin_74
    s_branch Lret_73
Lslow_75:
    s_mov_b32 s70, 524288
Lspin_77:
    ds_read_b128 v[16:19], v12 offset:160
    s_waitcnt lgkmcnt(0)
    v_or3_b32 v21, v16, v17, v18
    v_or_b32 v21, v21, v19
    s_nop 0
    v_readfirstlane_b32 s69, v21
    s_nop 0
    s_cmp_eq_u32 s69, 0
    s_cbranch_scc1 Lret_76
    s_sleep 2
    s_sub_u32 s70, s70, 1
    s_cmp_lg_u32 s70, 0
    s_cbranch_scc1 Lspin_77
    s_branch Lret_76
Lslow_78:
    s_mov_b32 s70, 524288
Lspin_80:
    ds_read_b32 v16, v12 offset:224
    s_waitcnt lgkmcnt(0)
    v_readfirstlane_b32 s69, v16
    s_nop 0
    s_cmp_eq_u32 s69, 0
    s_cbranch_scc1 Lret_79
    s_sleep 2
    s_sub_u32 s70, s70, 1
    s_cmp_lg_u32 s70, 0
    s_cbranch_scc1 Lspin_80
    s_branch Lret_79
L_K2:
    ds_read_b32 v20, v16 offset:0
    s_waitcnt lgkmcnt(0)
    v_readfirstlane_b32 s69, v20
    s_nop 0
    s_cmp_ge_u32 s69, 1
    s_cbranch_scc0 Lslow_81
Lret_82:
    ds_read_b128 v[40:43], v22 offset:0
    ds_read_b128 v[44:47], v22 offset:1024
    ds_read_b128 v[48:51], v22 offset:2048
    ds_read_b128 v[52:55], v22 offset:3072
    v_mov_b32 v100, 0
    v_mov_b32 v101, 0
    v_mov_b32 v102, 0
    v_mov_b32 v103, 0
    v_mov_b32 v105, 0
    v_mov_b32 v106, 0
    v_mov_b32 v107, 0
    v_and_b32 v17, 1, v0
    v_cmp_eq_u32 vcc, 1, v17
    v_lshl_add_u32 v17, v17, 4, s75
    s_waitcnt lgkmcnt(3)
    v_add_f32 v40, v40, v24
    v_add_f32 v41, v41, v25
    v_add_f32 v42, v42, v26
    v_add_f32 v43, v43, v27
    s_waitcnt lgkmcnt(2)
    v_add_f32 v44, v44, v28
    v_add_f32 v45, v45, v29
    v_add_f32 v46, v46, v30
    v_add_f32 v47, v47, v31
    s_waitcnt lgkmcnt(1)
    v_add_f32 v48, v48, v32
    v_add_f32 v49, v49, v33
    v_add_f32 v50, v50, v34
    v_add_f32 v51, v51, v35
    s_waitcnt lgkmcnt(0)
    v_add_f32 v52, v52, v36
    v_add_f32 v53, v53, v37
    v_add_f32 v54, v54, v38
    v_add_f32 v55, v55, v39
    v_cndmask_b32 v56, v52, v53, vcc
    v_cndmask_b32 v57, v54, v55, vcc
    v_cvt_pk_bf16_f32 v60, v47, v46
    v_cvt_pk_bf16_f32 v64, v48, v47
    v_cvt_pk_bf16_f32 v61, v45, v44
    v_cvt_pk_bf16_f32 v65, v46, v45
    v_cvt_pk_bf16_f32 v62, v43, v42
    v_cvt_pk_bf16_f32 v66, v44, v43
    v_cvt_pk_bf16_f32 v63, v41, v40
    v_cvt_pk_bf16_f32 v67, v42, v41
    ds_write_b128 v23, v[60:63] offset:3072
    ds_write_b128 v23, v[64:67] offset:7232
    v_cvt_pk_bf16_f32 v68, v51, v51
    v_cvt_pk_bf16_f32 v72, v51, v51
    v_cvt_pk_bf16_f32 v69, v50, v50
    v_cvt_pk_bf16_f32 v73, v51, v50
    v_cvt_pk_bf16_f32 v70, v50, v49
    v_cvt_pk_bf16_f32 v74, v50, v50
    v_cvt_pk_bf16_f32 v71, v49, v49
    v_cvt_pk_bf16_f32 v75, v49, v49
    ds_write_b128 v23, v[68:71] offset:2048
    ds_write_b128 v23, v[72:75] offset:6208
    v_cvt_pk_bf16_f32 v76, v53, v53
    v_cvt_pk_bf16_f32 v80, v53, v53
    v_cvt_pk_bf16_f32 v77, v53, v56
    v_cvt_pk_bf16_f32 v81, v53, v53
    v_cvt_pk_bf16_f32 v78, v52, v52
    v_cvt_pk_bf16_f32 v82, v56, v52
    v_cvt_pk_bf16_f32 v79, v52, v52
    v_cvt_pk_bf16_f32 v83, v52, v52
    ds_write_b128 v23, v[76:79] offset:1024
    ds_write_b128 v23, v[80:83] offset:5184
    v_cvt_pk_bf16_f32 v84, v55, v55
    v_cvt_pk_bf16_f32 v88, v55, v55
    v_cvt_pk_bf16_f32 v85, v55, v57
    v_cvt_pk_bf16_f32 v89, v55, v55
    v_cvt_pk_bf16_f32 v86, v54, v54
    v_cvt_pk_bf16_f32 v90, v57, v54
    v_cvt_pk_bf16_f32 v87, v54, v54
    v_cvt_pk_bf16_f32 v91, v54, v54
    ds_write_b128 v23, v[84:87] offset:0
    ds_write_b128 v23, v[88:91] offset:4160
    v_cvt_pk_bf16_f32 v104, v40, v100
    v_cndmask_b32 v104, v104, v100, vcc
    s_mov_b64 exec, 3
    ds_write_b128 v17, v[100:103] offset:4096
    ds_write_b128 v17, v[104:107] offset:8256
    s_mov_b64 exec, -1
    s_lshl2_add_u32 s64, s15, 163424
    v_mov_b32 v16, s64
    v_mov_b32 v17, 1
    ds_write_b32 v16, v17
    s_setprio 0
    s_mul_i32 s65, s15, 8704
    s_add_u32 s65, s65, 134174
    v_and_b32 v18, 15, v0
    v_lshrrev_b32 v19, 4, v0
    v_add_u32 v16, -1, v18
    v_or_b32 v16, 1, v16
    v_lshlrev_b32 v16, 1, v16
    v_lshlrev_b32 v17, 4, v19
    v_sub_u32 v17, v17, v16
    v_and_b32 v16, 1, v18
    v_xor_b32 v16, 1, v16
    v_mul_u32_u24 v16, 4160, v16
    v_add3_u32 v2, v17, v16, s65
    v_subrev_u32 v3, 1024, v2
    v_subrev_u32 v4, 2048, v2
    v_subrev_u32 v5, 3072, v2
    v_lshrrev_b32 v20, 1, v19
    v_and_b32 v21, 1, v19
    v_add_u32 v16, v18, v20
    v_lshlrev_b32 v17, 6, v16
    v_lshl_add_u32 v17, v21, 5, v17
    v_add_u32 v17, 148480, v17
    v_add_u32 v6, 0, v16
    v_bfe_u32 v6, v6, 2, 1
    v_xor_b32 v6, s15, v6
    v_lshl_add_u32 v168, v6, 4, v17
    v_xor_b32 v170, 16, v168
    v_add_u32 v6, 2, v16
    v_bfe_u32 v6, v6, 2, 1
    v_xor_b32 v6, s15, v6
    v_lshl_add_u32 v169, v6, 4, v17
    v_xor_b32 v171, 16, v169
    v_add_u32 v16, 15, v18
    v_lshlrev_b32 v17, 6, v16
    v_lshl_add_u32 v17, v20, 5, v17
    v_lshl_add_u32 v17, v21, 3, v17
    v_bfe_u32 v6, v16, 2, 1
    v_xor_b32 v6, s15, v6
    v_lshl_add_u32 v17, v6, 4, v17
    v_add_u32 v7, 148480, v17
    v_lshrrev_b32 v16, 2, v18
    v_lshlrev_b32 v16, 7, v16
    v_and_b32 v17, 3, v18
    v_lshl_add_u32 v16, v17, 4, v16
    v_lshrrev_b32 v17, 1, v19
    v_lshl_add_u32 v16, v17, 6, v16
    v_and_b32 v17, 1, v19
    v_lshl_add_u32 v8, v17, 9, v16
    s_lshl_b32 s1, s71, 12
    s_add_u32 s1, s1, 3145728
    s_lshl2_add_u32 s6, s71, 12288
    v_lshlrev_b32 v13, 16, v13
    s_setprio 0
    ds_read_b128 v[16:19], v12 offset:160
    s_waitcnt lgkmcnt(0)
    v_or3_b32 v21, v16, v17, v18
    v_or_b32 v21, v21, v19
    s_nop 0
    v_readfirstlane_b32 s69, v21
    s_nop 0
    s_cmp_eq_u32 s69, 0
    s_cbranch_scc0 Lslow_84
Lret_85:
    ds_read_b32 v16, v12 offset:224
    s_waitcnt lgkmcnt(0)
    v_readfirstlane_b32 s69, v16
    s_nop 0
    s_cmp_eq_u32 s69, 0
    s_cbranch_scc0 Lslow_87
Lret_88:
    ds_read2_b32 v[40:41], v2 offset0:240 offset1:241
    ds_read2_b32 v[42:43], v2 offset0:242 offset1:243
    ds_read_b128 v[64:67], v171 offset:896
    ds_read2_b32 v[44:45], v2 offset0:112 offset1:113
    ds_read2_b32 v[46:47], v2 offset0:114 offset1:115
    ds_read_b128 v[68:71], v171 offset:1920
    ds_read2_b32 v[48:49], v3 offset0:240 offset1:241
    ds_read2_b32 v[50:51], v3 offset0:242 offset1:243
    ds_read_b128 v[72:75], v171 offset:2944
    ds_read2_b32 v[52:53], v3 offset0:112 offset1:113
    ds_read2_b32 v[54:55], v3 offset0:114 offset1:115
    ds_read_b128 v[76:79], v171 offset:3968
    ds_read2_b32 v[56:57], v4 offset0:240 offset1:241
    ds_read2_b32 v[58:59], v4 offset0:242 offset1:243
    ds_read_b128 v[80:83], v171 offset:4992
    ds_read2_b32 v[60:61], v4 offset0:112 offset1:113
    ds_read2_b32 v[62:63], v4 offset0:114 offset1:115
    ds_read_b128 v[84:87], v171 offset:6016
    s_waitcnt lgkmcnt(15)
    v_mfma_f32_16x16x32_bf16 v[16:19], v[40:43], v[64:67], 0
    ds_read2_b32 v[88:89], v2 offset0:224 offset1:225
    s_waitcnt lgkmcnt(13)
    v_mfma_f32_16x16x32_bf16 v[20:23], v[40:43], v[68:71], 0
    ds_read2_b32 v[90:91], v2 offset0:226 offset1:227
    v_mfma_f32_16x16x32_bf16 v[20:23], v[44:47], v[64:67], v[20:23]
    ds_read_b128 v[112:115], v170 offset:768
    v_mfma_f32_16x16x32_bf16 v[24:27], v[44:47], v[68:71], 0
    ds_read2_b32 v[92:93], v2 offset0:96 offset1:97
    s_waitcnt lgkmcnt(13)
    v_mfma_f32_16x16x32_bf16 v[24:27], v[40:43], v[72:75], v[24:27]
    ds_read2_b32 v[94:95], v2 offset0:98 offset1:99
    v_mfma_f32_16x16x32_bf16 v[24:27], v[48:51], v[64:67], v[24:27]
    ds_read_b128 v[116:119], v170 offset:1792
    v_mfma_f32_16x16x32_bf16 v[28:31], v[44:47], v[72:75], 0
    ds_read2_b32 v[96:97], v3 offset0:224 offset1:225
    v_mfma_f32_16x16x32_bf16 v[28:31], v[48:51], v[68:71], v[28:31]
    ds_read2_b32 v[98:99], v3 offset0:226 offset1:227
    v_mfma_f32_16x16x32_bf16 v[32:35], v[48:51], v[72:75], 0
    ds_read_b128 v[120:123], v170 offset:2816
    s_waitcnt lgkmcnt(15)
    v_mfma_f32_16x16x32_bf16 v[28:31], v[40:43], v[76:79], v[28:31]
    ds_read2_b32 v[100:101], v3 offset0:96 offset1:97
    v_mfma_f32_16x16x32_bf16 v[28:31], v[52:55], v[64:67], v[28:31]
    ds_read2_b32 v[102:103], v3 offset0:98 offset1:99
    v_mfma_f32_16x16x32_bf16 v[32:35], v[44:47], v[76:79], v[32:35]
    ds_read_b128 v[124:127], v170 offset:3840
    v_mfma_f32_16x16x32_bf16 v[32:35], v[52:55], v[68:71], v[32:35]
    ds_read2_b32 v[104:105], v4 offset0:224 offset1:225
    v_mfma_f32_16x16x32_bf16 v[36:39], v[48:51], v[76:79], 0
    ds_read2_b32 v[106:107], v4 offset0:226 offset1:227
    v_mfma_f32_16x16x32_bf16 v[36:39], v[52:55], v[72:75], v[36:39]
    ds_read_b128 v[128:131], v170 offset:4864
    s_waitcnt lgkmcnt(15)
    v_mfma_f32_16x16x32_bf16 v[32:35], v[40:43], v[80:83], v[32:35]
    ds_read2_b32 v[108:109], v4 offset0:96 offset1:97
    v_mfma_f32_16x16x32_bf16 v[32:35], v[56:59], v[64:67], v[32:35]
    ds_read2_b32 v[110:111], v4 offset0:98 offset1:99
    v_mfma_f32_16x16x32_bf16 v[36:39], v[44:47], v[80:83], v[36:39]
    ds_read_b128 v[132:135], v170 offset:5888
    v_mfma_f32_16x16x32_bf16 v[36:39], v[56:59], v[68:71], v[36:39]
    v_mfma_f32_16x16x32_bf16 v[36:39], v[40:43], v[84:87], v[36:39]
    v_mfma_f32_16x16x32_bf16 v[36:39], v[60:63], v[64:67], v[36:39]
    s_waitcnt lgkmcnt(15)
    v_mfma_f32_16x16x32_bf16 v[16:19], v[88:91], v[112:115], v[16:19]
    ds_read2_b32 v[40:41], v2 offset0:208 offset1:209
    s_waitcnt lgkmcnt(13)
    v_mfma_f32_16x16x32_bf16 v[20:23], v[88:91], v[116:119], v[20:23]
    ds_read2_b32 v[42:43], v2 offset0:210 offset1:211
    v_mfma_f32_16x16x32_bf16 v[20:23], v[92:95], v[112:115], v[20:23]
    ds_read_b128 v[64:67], v169 offset:640
    v_mfma_f32_16x16x32_bf16 v[24:27], v[92:95], v[116:119], v[24:27]
    ds_read2_b32 v[44:45], v2 offset0:80 offset1:81
    s_waitcnt lgkmcnt(13)
    v_mfma_f32_16x16x32_bf16 v[24:27], v[88:91], v[120:123], v[24:27]
    ds_read2_b32 v[46:47], v2 offset0:82 offset1:83
    v_mfma_f32_16x16x32_bf16 v[24:27], v[96:99], v[112:115], v[24:27]
    ds_read_b128 v[68:71], v169 offset:1664
    v_mfma_f32_16x16x32_bf16 v[28:31], v[92:95], v[120:123], v[28:31]
    ds_read2_b32 v[48:49], v3 offset0:208 offset1:209
    v_mfma_f32_16x16x32_bf16 v[28:31], v[96:99], v[116:119], v[28:31]
    ds_read2_b32 v[50:51], v3 offset0:210 offset1:211
    v_mfma_f32_16x16x32_bf16 v[32:35], v[96:99], v[120:123], v[32:35]
    ds_read_b128 v[72:75], v169 offset:2688
    s_waitcnt lgkmcnt(15)
    v_mfma_f32_16x16x32_bf16 v[28:31], v[88:91], v[124:127], v[28:31]
    ds_read2_b32 v[52:53], v3 offset0:80 offset1:81
    v_mfma_f32_16x16x32_bf16 v[28:31], v[100:103], v[112:115], v[28:31]
    ds_read2_b32 v[54:55], v3 offset0:82 offset1:83
    v_mfma_f32_16x16x32_bf16 v[32:35], v[92:95], v[124:127], v[32:35]
    ds_read_b128 v[76:79], v169 offset:3712
    v_mfma_f32_16x16x32_bf16 v[32:35], v[100:103], v[116:119], v[32:35]
    ds_read2_b32 v[56:57], v4 offset0:208 offset1:209
    v_mfma_f32_16x16x32_bf16 v[36:39], v[96:99], v[124:127], v[36:39]
    ds_read2_b32 v[58:59], v4 offset0:210 offset1:211
    v_mfma_f32_16x16x32_bf16 v[36:39], v[100:103], v[120:123], v[36:39]
    ds_read_b128 v[80:83], v169 offset:4736
    s_waitcnt lgkmcnt(15)
    v_mfma_f32_16x16x32_bf16 v[32:35], v[88:91], v[128:131], v[32:35]
    ds_read2_b32 v[60:61], v4 offset0:80 offset1:81
    v_mfma_f32_16x16x32_bf16 v[32:35], v[104:107], v[112:115], v[32:35]
    ds_read2_b32 v[62:63], v4 offset0:82 offset1:83
    v_mfma_f32_16x16x32_bf16 v[36:39], v[92:95], v[128:131], v[36:39]
    ds_read_b128 v[84:87], v169 offset:5760
    v_mfma_f32_16x16x32_bf16 v[36:39], v[104:107], v[116:119], v[36:39]
    v_mfma_f32_16x16x32_bf16 v[36:39], v[88:91], v[132:135], v[36:39]
    v_mfma_f32_16x16x32_bf16 v[36:39], v[108:111], v[112:115], v[36:39]
    s_waitcnt lgkmcnt(15)
    v_mfma_f32_16x16x32_bf16 v[16:19], v[40:43], v[64:67], v[16:19]
    ds_read2_b32 v[88:89], v2 offset0:192 offset1:193
    s_waitcnt lgkmcnt(13)
    v_mfma_f32_16x16x32_bf16 v[20:23], v[40:43], v[68:71], v[20:23]
    ds_read2_b32 v[90:91], v2 offset0:194 offset1:195
    v_mfma_f32_16x16x32_bf16 v[20:23], v[44:47], v[64:67], v[20:23]
    ds_read_b128 v[112:115], v168 offset:512
    v_mfma_f32_16x16x32_bf16 v[24:27], v[44:47], v[68:71], v[24:27]
    ds_read2_b32 v[92:93], v2 offset0:64 offset1:65
    s_waitcnt lgkmcnt(13)
    v_mfma_f32_16x16x32_bf16 v[24:27], v[40:43], v[72:75], v[24:27]
    ds_read2_b32 v[94:95], v2 offset0:66 offset1:67
    v_mfma_f32_16x16x32_bf16 v[24:27], v[48:51], v[64:67], v[24:27]
    ds_read_b128 v[116:119], v168 offset:1536
    v_mfma_f32_16x16x32_bf16 v[28:31], v[44:47], v[72:75], v[28:31]
    ds_read2_b32 v[96:97], v3 offset0:192 offset1:193
    v_mfma_f32_16x16x32_bf16 v[28:31], v[48:51], v[68:71], v[28:31]
    ds_read2_b32 v[98:99], v3 offset0:194 offset1:195
    v_mfma_f32_16x16x32_bf16 v[32:35], v[48:51], v[72:75], v[32:35]
    ds_read_b128 v[120:123], v168 offset:2560
    s_waitcnt lgkmcnt(15)
    v_mfma_f32_16x16x32_bf16 v[28:31], v[40:43], v[76:79], v[28:31]
    ds_read2_b32 v[100:101], v3 offset0:64 offset1:65
    v_mfma_f32_16x16x32_bf16 v[28:31], v[52:55], v[64:67], v[28:31]
    ds_read2_b32 v[102:103], v3 offset0:66 offset1:67
    v_mfma_f32_16x16x32_bf16 v[32:35], v[44:47], v[76:79], v[32:35]
    ds_read_b128 v[124:127], v168 offset:3584
    v_mfma_f32_16x16x32_bf16 v[32:35], v[52:55], v[68:71], v[32:35]
    ds_read2_b32 v[104:105], v4 offset0:192 offset1:193
    v_mfma_f32_16x16x32_bf16 v[36:39], v[48:51], v[76:79], v[36:39]
    ds_read2_b32 v[106:107], v4 offset0:194 offset1:195
    v_mfma_f32_16x16x32_bf16 v[36:39], v[52:55], v[72:75], v[36:39]
    ds_read_b128 v[128:131], v168 offset:4608
    s_waitcnt lgkmcnt(15)
    v_mfma_f32_16x16x32_bf16 v[32:35], v[40:43], v[80:83], v[32:35]
    ds_read2_b32 v[108:109], v4 offset0:64 offset1:65
    v_mfma_f32_16x16x32_bf16 v[32:35], v[56:59], v[64:67], v[32:35]
    ds_read2_b32 v[110:111], v4 offset0:66 offset1:67
    v_mfma_f32_16x16x32_bf16 v[36:39], v[44:47], v[80:83], v[36:39]
    ds_read_b128 v[132:135], v168 offset:5632
    v_mfma_f32_16x16x32_bf16 v[36:39], v[56:59], v[68:71], v[36:39]
    v_mfma_f32_16x16x32_bf16 v[36:39], v[40:43], v[84:87], v[36:39]
    v_mfma_f32_16x16x32_bf16 v[36:39], v[60:63], v[64:67], v[36:39]
    s_waitcnt lgkmcnt(15)
    v_mfma_f32_16x16x32_bf16 v[16:19], v[88:91], v[112:115], v[16:19]
    ds_read2_b32 v[40:41], v2 offset0:176 offset1:177
    s_waitcnt lgkmcnt(13)
    v_mfma_f32_16x16x32_bf16 v[20:23], v[88:91], v[116:119], v[20:23]
    ds_read2_b32 v[42:43], v2 offset0:178 offset1:179
    v_mfma_f32_16x16x32_bf16 v[20:23], v[92:95], v[112:115], v[20:23]
    ds_read_b128 v[64:67], v171 offset:384
    v_mfma_f32_16x16x32_bf16 v[24:27], v[92:95], v[116:119], v[24:27]
    ds_read2_b32 v[44:45], v2 offset0:48 offset1:49
    s_waitcnt lgkmcnt(13)
    v_mfma_f32_16x16x32_bf16 v[24:27], v[88:91], v[120:123], v[24:27]
    ds_read2_b32 v[46:47], v2 offset0:50 offset1:51
    v_mfma_f32_16x16x32_bf16 v[24:27], v[96:99], v[112:115], v[24:27]
    ds_read_b128 v[68:71], v171 offset:1408
    v_mfma_f32_16x16x32_bf16 v[28:31], v[92:95], v[120:123], v[28:31]
    ds_read2_b32 v[48:49], v3 offset0:176 offset1:177
    v_mfma_f32_16x16x32_bf16 v[28:31], v[96:99], v[116:119], v[28:31]
    ds_read2_b32 v[50:51], v3 offset0:178 offset1:179
    v_mfma_f32_16x16x32_bf16 v[32:35], v[96:99], v[120:123], v[32:35]
    ds_read_b128 v[72:75], v171 offset:2432
    s_waitcnt lgkmcnt(15)
    v_mfma_f32_16x16x32_bf16 v[28:31], v[88:91], v[124:127], v[28:31]
    ds_read2_b32 v[52:53], v3 offset0:48 offset1:49
    v_mfma_f32_16x16x32_bf16 v[28:31], v[100:103], v[112:115], v[28:31]
    ds_read2_b32 v[54:55], v3 offset0:50 offset1:51
    v_mfma_f32_16x16x32_bf16 v[32:35], v[92:95], v[124:127], v[32:35]
    ds_read_b128 v[76:79], v171 offset:3456
    v_mfma_f32_16x16x32_bf16 v[32:35], v[100:103], v[116:119], v[32:35]
    ds_read2_b32 v[56:57], v4 offset0:176 offset1:177
    v_mfma_f32_16x16x32_bf16 v[36:39], v[96:99], v[124:127], v[36:39]
    ds_read2_b32 v[58:59], v4 offset0:178 offset1:179
    v_mfma_f32_16x16x32_bf16 v[36:39], v[100:103], v[120:123], v[36:39]
    ds_read_b128 v[80:83], v171 offset:4480
    s_waitcnt lgkmcnt(15)
    v_mfma_f32_16x16x32_bf16 v[32:35], v[88:91], v[128:131], v[32:35]
    ds_read2_b32 v[60:61], v4 offset0:48 offset1:49
    v_mfma_f32_16x16x32_bf16 v[32:35], v[104:107], v[112:115], v[32:35]
    ds_read2_b32 v[62:63], v4 offset0:50 offset1:51
    v_mfma_f32_16x16x32_bf16 v[36:39], v[92:95], v[128:131], v[36:39]
    ds_read_b128 v[84:87], v171 offset:5504
    v_mfma_f32_16x16x32_bf16 v[36:39], v[104:107], v[116:119], v[36:39]
    v_mfma_f32_16x16x32_bf16 v[36:39], v[88:91], v[132:135], v[36:39]
    v_mfma_f32_16x16x32_bf16 v[36:39], v[108:111], v[112:115], v[36:39]
    s_waitcnt lgkmcnt(15)
    v_mfma_f32_16x16x32_bf16 v[16:19], v[40:43], v[64:67], v[16:19]
    ds_read2_b32 v[88:89], v2 offset0:160 offset1:161
    s_waitcnt lgkmcnt(13)
    v_mfma_f32_16x16x32_bf16 v[20:23], v[40:43], v[68:71], v[20:23]
    ds_read2_b32 v[90:91], v2 offset0:162 offset1:163
    v_mfma_f32_16x16x32_bf16 v[20:23], v[44:47], v[64:67], v[20:23]
    ds_read_b128 v[112:115], v170 offset:256
    v_mfma_f32_16x16x32_bf16 v[24:27], v[44:47], v[68:71], v[24:27]
    ds_read2_b32 v[92:93], v2 offset0:32 offset1:33
    s_waitcnt lgkmcnt(13)
    v_mfma_f32_16x16x32_bf16 v[24:27], v[40:43], v[72:75], v[24:27]
    ds_read2_b32 v[94:95], v2 offset0:34 offset1:35
    v_mfma_f32_16x16x32_bf16 v[24:27], v[48:51], v[64:67], v[24:27]
    ds_read_b128 v[116:119], v170 offset:1280
    v_mfma_f32_16x16x32_bf16 v[28:31], v[44:47], v[72:75], v[28:31]
    ds_read2_b32 v[96:97], v3 offset0:160 offset1:161
    v_mfma_f32_16x16x32_bf16 v[28:31], v[48:51], v[68:71], v[28:31]
    ds_read2_b32 v[98:99], v3 offset0:162 offset1:163
    v_mfma_f32_16x16x32_bf16 v[32:35], v[48:51], v[72:75], v[32:35]
    ds_read_b128 v[120:123], v170 offset:2304
    s_waitcnt lgkmcnt(15)
    v_mfma_f32_16x16x32_bf16 v[28:31], v[40:43], v[76:79], v[28:31]
    ds_read2_b32 v[100:101], v3 offset0:32 offset1:33
    v_mfma_f32_16x16x32_bf16 v[28:31], v[52:55], v[64:67], v[28:31]
    ds_read2_b32 v[102:103], v3 offset0:34 offset1:35
    v_mfma_f32_16x16x32_bf16 v[32:35], v[44:47], v[76:79], v[32:35]
    ds_read_b128 v[124:127], v170 offset:3328
    v_mfma_f32_16x16x32_bf16 v[32:35], v[52:55], v[68:71], v[32:35]
    ds_read2_b32 v[104:105], v4 offset0:160 offset1:161
    v_mfma_f32_16x16x32_bf16 v[36:39], v[48:51], v[76:79], v[36:39]
    ds_read2_b32 v[106:107], v4 offset0:162 offset1:163
    v_mfma_f32_16x16x32_bf16 v[36:39], v[52:55], v[72:75], v[36:39]
    ds_read_b128 v[128:131], v170 offset:4352
    s_waitcnt lgkmcnt(15)
    v_mfma_f32_16x16x32_bf16 v[32:35], v[40:43], v[80:83], v[32:35]
    ds_read2_b32 v[108:109], v4 offset0:32 offset1:33
    v_mfma_f32_16x16x32_bf16 v[32:35], v[56:59], v[64:67], v[32:35]
    ds_read2_b32 v[110:111], v4 offset0:34 offset1:35
    v_mfma_f32_16x16x32_bf16 v[36:39], v[44:47], v[80:83], v[36:39]
    ds_read_b128 v[132:135], v170 offset:5376
    v_mfma_f32_16x16x32_bf16 v[36:39], v[56:59], v[68:71], v[36:39]
    v_mfma_f32_16x16x32_bf16 v[36:39], v[40:43], v[84:87], v[36:39]
    v_mfma_f32_16x16x32_bf16 v[36:39], v[60:63], v[64:67], v[36:39]
    s_waitcnt lgkmcnt(15)
    v_mfma_f32_16x16x32_bf16 v[16:19], v[88:91], v[112:115], v[16:19]
    ds_read2_b32 v[40:41], v2 offset0:144 offset1:145
    s_waitcnt lgkmcnt(13)
    v_mfma_f32_16x16x32_bf16 v[20:23], v[88:91], v[116:119], v[20:23]
    ds_read2_b32 v[42:43], v2 offset0:146 offset1:147
    v_mfma_f32_16x16x32_bf16 v[20:23], v[92:95], v[112:115], v[20:23]
    ds_read_b128 v[64:67], v169 offset:128
    v_mfma_f32_16x16x32_bf16 v[24:27], v[92:95], v[116:119], v[24:27]
    ds_read2_b32 v[44:45], v2 offset0:16 offset1:17
    s_waitcnt lgkmcnt(13)
    v_mfma_f32_16x16x32_bf16 v[24:27], v[88:91], v[120:123], v[24:27]
    ds_read2_b32 v[46:47], v2 offset0:18 offset1:19
    v_mfma_f32_16x16x32_bf16 v[24:27], v[96:99], v[112:115], v[24:27]
    ds_read_b128 v[68:71], v169 offset:1152
    v_mfma_f32_16x16x32_bf16 v[28:31], v[92:95], v[120:123], v[28:31]
    ds_read2_b32 v[48:49], v3 offset0:144 offset1:145
    v_mfma_f32_16x16x32_bf16 v[28:31], v[96:99], v[116:119], v[28:31]
    ds_read2_b32 v[50:51], v3 offset0:146 offset1:147
    v_mfma_f32_16x16x32_bf16 v[32:35], v[96:99], v[120:123], v[32:35]
    ds_read_b128 v[72:75], v169 offset:2176
    s_waitcnt lgkmcnt(15)
    v_mfma_f32_16x16x32_bf16 v[28:31], v[88:91], v[124:127], v[28:31]
    ds_read2_b32 v[52:53], v3 offset0:16 offset1:17
    v_mfma_f32_16x16x32_bf16 v[28:31], v[100:103], v[112:115], v[28:31]
    ds_read2_b32 v[54:55], v3 offset0:18 offset1:19
    v_mfma_f32_16x16x32_bf16 v[32:35], v[92:95], v[124:127], v[32:35]
    ds_read_b128 v[76:79], v169 offset:3200
    v_mfma_f32_16x16x32_bf16 v[32:35], v[100:103], v[116:119], v[32:35]
    ds_read2_b32 v[56:57], v4 offset0:144 offset1:145
    v_mfma_f32_16x16x32_bf16 v[36:39], v[96:99], v[124:127], v[36:39]
    ds_read2_b32 v[58:59], v4 offset0:146 offset1:147
    v_mfma_f32_16x16x32_bf16 v[36:39], v[100:103], v[120:123], v[36:39]
    ds_read_b128 v[80:83], v169 offset:4224
    s_waitcnt lgkmcnt(15)
    v_mfma_f32_16x16x32_bf16 v[32:35], v[88:91], v[128:131], v[32:35]
    ds_read2_b32 v[60:61], v4 offset0:16 offset1:17
    v_mfma_f32_16x16x32_bf16 v[32:35], v[104:107], v[112:115], v[32:35]
    ds_read2_b32 v[62:63], v4 offset0:18 offset1:19
    v_mfma_f32_16x16x32_bf16 v[36:39], v[92:95], v[128:131], v[36:39]
    ds_read_b128 v[84:87], v169 offset:5248
    v_mfma_f32_16x16x32_bf16 v[36:39], v[104:107], v[116:119], v[36:39]
    v_mfma_f32_16x16x32_bf16 v[36:39], v[88:91], v[132:135], v[36:39]
    v_mfma_f32_16x16x32_bf16 v[36:39], v[108:111], v[112:115], v[36:39]
    s_waitcnt lgkmcnt(15)
    v_mfma_f32_16x16x32_bf16 v[16:19], v[40:43], v[64:67], v[16:19]
    ds_read2_b32 v[88:89], v2 offset0:128 offset1:129
    s_waitcnt lgkmcnt(13)
    v_mfma_f32_16x16x32_bf16 v[20:23], v[40:43], v[68:71], v[20:23]
    ds_read2_b32 v[90:91], v2 offset0:130 offset1:131
    v_mfma_f32_16x16x32_bf16 v[20:23], v[44:47], v[64:67], v[20:23]
    ds_read_b128 v[112:115], v168 offset:0
    v_mfma_f32_16x16x32_bf16 v[24:27], v[44:47], v[68:71], v[24:27]
    ds_read2_b32 v[92:93], v2 offset0:0 offset1:1
    s_waitcnt lgkmcnt(13)
    v_mfma_f32_16x16x32_bf16 v[24:27], v[40:43], v[72:75], v[24:27]
    ds_read2_b32 v[94:95], v2 offset0:2 offset1:3
    v_mfma_f32_16x16x32_bf16 v[24:27], v[48:51], v[64:67], v[24:27]
    ds_read_b128 v[116:119], v168 offset:1024
    v_mfma_f32_16x16x32_bf16 v[28:31], v[44:47], v[72:75], v[28:31]
    ds_read2_b32 v[96:97], v3 offset0:128 offset1:129
    v_mfma_f32_16x16x32_bf16 v[28:31], v[48:51], v[68:71], v[28:31]
    ds_read2_b32 v[98:99], v3 offset0:130 offset1:131
    v_mfma_f32_16x16x32_bf16 v[32:35], v[48:51], v[72:75], v[32:35]
    ds_read_b128 v[120:123], v168 offset:2048
    s_waitcnt lgkmcnt(15)
    v_mfma_f32_16x16x32_bf16 v[28:31], v[40:43], v[76:79], v[28:31]
    ds_read2_b32 v[100:101], v3 offset0:0 offset1:1
    v_mfma_f32_16x16x32_bf16 v[28:31], v[52:55], v[64:67], v[28:31]
    ds_read2_b32 v[102:103], v3 offset0:2 offset1:3
    v_mfma_f32_16x16x32_bf16 v[32:35], v[44:47], v[76:79], v[32:35]
    ds_read_b128 v[124:127], v168 offset:3072
    v_mfma_f32_16x16x32_bf16 v[32:35], v[52:55], v[68:71], v[32:35]
    ds_read2_b32 v[104:105], v4 offset0:128 offset1:129
    v_mfma_f32_16x16x32_bf16 v[36:39], v[48:51], v[76:79], v[36:39]
    ds_read2_b32 v[106:107], v4 offset0:130 offset1:131
    v_mfma_f32_16x16x32_bf16 v[36:39], v[52:55], v[72:75], v[36:39]
    ds_read_b128 v[128:131], v168 offset:4096
    s_waitcnt lgkmcnt(15)
    v_mfma_f32_16x16x32_bf16 v[32:35], v[40:43], v[80:83], v[32:35]
    ds_read2_b32 v[108:109], v4 offset0:0 offset1:1
    v_mfma_f32_16x16x32_bf16 v[32:35], v[56:59], v[64:67], v[32:35]
    ds_read2_b32 v[110:111], v4 offset0:2 offset1:3
    v_mfma_f32_16x16x32_bf16 v[36:39], v[44:47], v[80:83], v[36:39]
    ds_read_b128 v[132:135], v168 offset:5120
    v_mfma_f32_16x16x32_bf16 v[36:39], v[56:59], v[68:71], v[36:39]
    v_mfma_f32_16x16x32_bf16 v[36:39], v[40:43], v[84:87], v[36:39]
    v_mfma_f32_16x16x32_bf16 v[36:39], v[60:63], v[64:67], v[36:39]
    s_waitcnt lgkmcnt(15)
    v_mfma_f32_16x16x32_bf16 v[16:19], v[88:91], v[112:115], v[16:19]
    ds_read_b64 v[176:177], v7 offset:0
    s_waitcnt lgkmcnt(13)
    v_mfma_f32_16x16x32_bf16 v[20:23], v[88:91], v[116:119], v[20:23]
    ds_read_b64 v[178:179], v7 offset:1024
    v_mfma_f32_16x16x32_bf16 v[20:23], v[92:95], v[112:115], v[20:23]
    ds_read_b64 v[180:181], v7 offset:2048
    v_mfma_f32_16x16x32_bf16 v[24:27], v[92:95], v[116:119], v[24:27]
    ds_read_b64 v[182:183], v7 offset:3072
    s_waitcnt lgkmcnt(13)
    v_mfma_f32_16x16x32_bf16 v[24:27], v[88:91], v[120:123], v[24:27]
    ds_read_b64 v[184:185], v7 offset:4096
    v_mfma_f32_16x16x32_bf16 v[24:27], v[96:99], v[112:115], v[24:27]
    ds_read_b64 v[186:187], v7 offset:5120
    v_mfma_f32_16x16x32_bf16 v[28:31], v[92:95], v[120:123], v[28:31]
    v_mfma_f32_16x16x32_bf16 v[28:31], v[96:99], v[116:119], v[28:31]
    v_mfma_f32_16x16x32_bf16 v[32:35], v[96:99], v[120:123], v[32:35]
    s_waitcnt lgkmcnt(12)
    v_mfma_f32_16x16x32_bf16 v[28:31], v[88:91], v[124:127], v[28:31]
    v_mfma_f32_16x16x32_bf16 v[28:31], v[100:103], v[112:115], v[28:31]
    v_mfma_f32_16x16x32_bf16 v[32:35], v[92:95], v[124:127], v[32:35]
    v_mfma_f32_16x16x32_bf16 v[32:35], v[100:103], v[116:119], v[32:35]
    v_mfma_f32_16x16x32_bf16 v[36:39], v[96:99], v[124:127], v[36:39]
    v_mfma_f32_16x16x32_bf16 v[36:39], v[100:103], v[120:123], v[36:39]
    s_waitcnt lgkmcnt(9)
    v_mfma_f32_16x16x32_bf16 v[32:35], v[88:91], v[128:131], v[32:35]
    v_mfma_f32_16x16x32_bf16 v[32:35], v[104:107], v[112:115], v[32:35]
    v_mfma_f32_16x16x32_bf16 v[36:39], v[92:95], v[128:131], v[36:39]
    v_mfma_f32_16x16x32_bf16 v[36:39], v[104:107], v[116:119], v[36:39]
    s_waitcnt lgkmcnt(6)
    v_mfma_f32_16x16x32_bf16 v[36:39], v[88:91], v[132:135], v[36:39]
    v_mfma_f32_16x16x32_bf16 v[36:39], v[108:111], v[112:115], v[36:39]
    s_waitcnt lgkmcnt(0)
    s_setprio 2
    v_lshlrev_b32 v68, 16, v176
    v_and_b32 v69, 0xffff0000, v176
    v_lshlrev_b32 v70, 16, v177
    v_and_b32 v71, 0xffff0000, v177
    v_lshlrev_b32 v72, 16, v178
    v_and_b32 v73, 0xffff0000, v178
    v_lshlrev_b32 v74, 16, v179
    v_and_b32 v75, 0xffff0000, v179
    v_mul_f32 v68, v13, v68
    v_mul_f32 v69, v13, v69
    v_mul_f32 v70, v13, v70
    v_mul_f32 v71, v13, v71
    v_mul_f32 v72, v13, v72
    v_mul_f32 v73, v13, v73
    v_mul_f32 v74, v13, v74
    v_mul_f32 v75, v13, v75
    v_cvt_pk_bf16_f32 v84, v16, v17
    v_cvt_pk_bf16_f32 v85, v18, v19
    v_cvt_pk_bf16_f32 v86, v20, v21
    v_cvt_pk_bf16_f32 v87, v22, v23
    v_cvt_pk_bf16_f32 v88, v68, v69
    v_lshlrev_b32 v76, 16, v84
    v_and_b32 v77, 0xffff0000, v84
    v_cvt_pk_bf16_f32 v89, v70, v71
    v_lshlrev_b32 v78, 16, v85
    v_and_b32 v79, 0xffff0000, v85
    v_cvt_pk_bf16_f32 v90, v72, v73
    v_lshlrev_b32 v80, 16, v86
    v_and_b32 v81, 0xffff0000, v86
    v_cvt_pk_bf16_f32 v91, v74, v75
    v_lshlrev_b32 v82, 16, v87
    v_and_b32 v83, 0xffff0000, v87
    v_lshlrev_b32 v68, 16, v88
    v_and_b32 v69, 0xffff0000, v88
    v_lshlrev_b32 v70, 16, v89
    v_and_b32 v71, 0xffff0000, v89
    v_lshlrev_b32 v72, 16, v90
    v_and_b32 v73, 0xffff0000, v90
    v_lshlrev_b32 v74, 16, v91
    v_and_b32 v75, 0xffff0000, v91
    v_add_f32 v68, v68, v76
    v_add_f32 v69, v69, v77
    v_add_f32 v70, v70, v78
    v_add_f32 v71, v71, v79
    v_add_f32 v72, v72, v80
    v_add_f32 v73, v73, v81
    v_add_f32 v74, v74, v82
    v_add_f32 v75, v75, v83
    v_cvt_pk_bf16_f32 v56, v68, v69
    v_cvt_pk_bf16_f32 v57, v70, v71
    v_cvt_pk_bf16_f32 v58, v72, v73
    v_cvt_pk_bf16_f32 v59, v74, v75
    s_nop 0
    v_permlane16_swap_b32 v56, v58
    v_permlane16_swap_b32 v57, v59
    buffer_store_dwordx4 v[56:59], v8, s[56:59], s1 offen offset:0 sc1
    v_lshlrev_b32 v68, 16, v180
    v_and_b32 v69, 0xffff0000, v180
    v_lshlrev_b32 v70, 16, v181
    v_and_b32 v71, 0xffff0000, v181
    v_lshlrev_b32 v72, 16, v182
    v_and_b32 v73, 0xffff0000, v182
    v_lshlrev_b32 v74, 16, v183
    v_and_b32 v75, 0xffff0000, v183
    v_mul_f32 v68, v13, v68
    v_mul_f32 v69, v13, v69
    v_mul_f32 v70, v13, v70
    v_mul_f32 v71, v13, v71
    v_mul_f32 v72, v13, v72
    v_mul_f32 v73, v13, v73
    v_mul_f32 v74, v13, v74
    v_mul_f32 v75, v13, v75
    v_cvt_pk_bf16_f32 v84, v24, v25
    v_cvt_pk_bf16_f32 v85, v26, v27
    v_cvt_pk_bf16_f32 v86, v28, v29
    v_cvt_pk_bf16_f32 v87, v30, v31
    v_cvt_pk_bf16_f32 v88, v68, v69
    v_lshlrev_b32 v76, 16, v84
    v_and_b32 v77, 0xffff0000, v84
    v_cvt_pk_bf16_f32 v89, v70, v71
    v_lshlrev_b32 v78, 16, v85
    v_and_b32 v79, 0xffff0000, v85
    v_cvt_pk_bf16_f32 v90, v72, v73
    v_lshlrev_b32 v80, 16, v86
    v_and_b32 v81, 0xffff0000, v86
    v_cvt_pk_bf16_f32 v91, v74, v75
    v_lshlrev_b32 v82, 16, v87
    v_and_b32 v83, 0xffff0000, v87
    v_lshlrev_b32 v68, 16, v88
    v_and_b32 v69, 0xffff0000, v88
    v_lshlrev_b32 v70, 16, v89
    v_and_b32 v71, 0xffff0000, v89
    v_lshlrev_b32 v72, 16, v90
    v_and_b32 v73, 0xffff0000, v90
    v_lshlrev_b32 v74, 16, v91
    v_and_b32 v75, 0xffff0000, v91
    v_add_f32 v68, v68, v76
    v_add_f32 v69, v69, v77
    v_add_f32 v70, v70, v78
    v_add_f32 v71, v71, v79
    v_add_f32 v72, v72, v80
    v_add_f32 v73, v73, v81
    v_add_f32 v74, v74, v82
    v_add_f32 v75, v75, v83
    v_cvt_pk_bf16_f32 v60, v68, v69
    v_cvt_pk_bf16_f32 v61, v70, v71
    v_cvt_pk_bf16_f32 v62, v72, v73
    v_cvt_pk_bf16_f32 v63, v74, v75
    s_nop 0
    v_permlane16_swap_b32 v60, v62
    v_permlane16_swap_b32 v61, v63
    buffer_store_dwordx4 v[60:63], v8, s[56:59], s1 offen offset:1024 sc1
    v_lshlrev_b32 v68, 16, v184
    v_and_b32 v69, 0xffff0000, v184
    v_lshlrev_b32 v70, 16, v185
    v_and_b32 v71, 0xffff0000, v185
    v_lshlrev_b32 v72, 16, v186
    v_and_b32 v73, 0xffff0000, v186
    v_lshlrev_b32 v74, 16, v187
    v_and_b32 v75, 0xffff0000, v187
    v_mul_f32 v68, v13, v68
    v_mul_f32 v69, v13, v69
    v_mul_f32 v70, v13, v70
    v_mul_f32 v71, v13, v71
    v_mul_f32 v72, v13, v72
    v_mul_f32 v73, v13, v73
    v_mul_f32 v74, v13, v74
    v_mul_f32 v75, v13, v75
    v_cvt_pk_bf16_f32 v84, v32, v33
    v_cvt_pk_bf16_f32 v85, v34, v35
    v_cvt_pk_bf16_f32 v86, v36, v37
    v_cvt_pk_bf16_f32 v87, v38, v39
    v_cvt_pk_bf16_f32 v88, v68, v69
    v_lshlrev_b32 v76, 16, v84
    v_and_b32 v77, 0xffff0000, v84
    v_cvt_pk_bf16_f32 v89, v70, v71
    v_lshlrev_b32 v78, 16, v85
    v_and_b32 v79, 0xffff0000, v85
    v_cvt_pk_bf16_f32 v90, v72, v73
    v_lshlrev_b32 v80, 16, v86
    v_and_b32 v81, 0xffff0000, v86
    v_cvt_pk_bf16_f32 v91, v74, v75
    v_lshlrev_b32 v82, 16, v87
    v_and_b32 v83, 0xffff0000, v87
    v_lshlrev_b32 v68, 16, v88
    v_and_b32 v69, 0xffff0000, v88
    v_lshlrev_b32 v70, 16, v89
    v_and_b32 v71, 0xffff0000, v89
    v_lshlrev_b32 v72, 16, v90
    v_and_b32 v73, 0xffff0000, v90
    v_lshlrev_b32 v74, 16, v91
    v_and_b32 v75, 0xffff0000, v91
    v_add_f32 v68, v68, v76
    v_add_f32 v69, v69, v77
    v_add_f32 v70, v70, v78
    v_add_f32 v71, v71, v79
    v_add_f32 v72, v72, v80
    v_add_f32 v73, v73, v81
    v_add_f32 v74, v74, v82
    v_add_f32 v75, v75, v83
    v_cvt_pk_bf16_f32 v64, v68, v69
    v_cvt_pk_bf16_f32 v65, v70, v71
    v_cvt_pk_bf16_f32 v66, v72, v73
    v_cvt_pk_bf16_f32 v67, v74, v75
    s_nop 0
    v_permlane16_swap_b32 v64, v66
    v_permlane16_swap_b32 v65, v67
    buffer_store_dwordx4 v[64:67], v8, s[56:59], s1 offen offset:2048 sc1
    s_lshl2_add_u32 m0, s3, 163296
    s_mov_b64 exec, 1
    buffer_load_dword off, s[60:63], 0 lds
    s_mov_b64 exec, -1
    v_and_b32 v242, 7, v0
    v_lshrrev_b32 v240, 3, v0
    v_lshlrev_b32 v241, 1, v242
    v_xor_b32 v241, v241, v240
    v_lshlrev_b32 v241, 4, v241
    v_lshl_add_u32 v241, v240, 8, v241
    s_and_b32 s64, s3, 3
    s_lshl_b32 s64, s64, 11
    s_cmp_lt_u32 s3, 4
    s_cselect_b32 s65, 98304, 0
    s_add_u32 s64, s64, s65
    v_add_u32 v232, s64, v241
    v_xor_b32 v233, 16, v232
    v_xor_b32 v241, v242, v240
    v_lshlrev_b32 v241, 4, v241
    v_lshl_add_u32 v241, v240, 7, v241
    s_lshl_b32 s64, s3, 10
    s_add_u32 s64, s64, 148480
    v_add_u32 v234, s64, v241
    s_lshl_b32 s64, s3, 5
    s_add_u32 s64, s64, 163456
    v_lshl_add_u32 v235, v240, 2, s64
    v_lshlrev_b32 v241, 4, v242
    v_lshl_add_u32 v236, v240, 10, v241
    s_lshl3_add_u32 s64, s8, s3
    s_lshl_b32 s64, s64, 13
    s_lshl_b32 s65, s9, 7
    s_add_u32 s64, s64, s65
    v_add_u32 v236, s64, v236
    s_waitcnt vmcnt(1)
    s_buffer_atomic_swap s13, s[56:59], s6
    s_add_u32 s69, s6, 8192
    s_buffer_atomic_swap s13, s[56:59], s69
    s_add_u32 s69, s6, 16384
    s_buffer_atomic_swap s13, s[56:59], s69
    s_add_u32 s69, s6, 24576
    s_buffer_atomic_swap s13, s[56:59], s69
L_late:
    s_and_b32 s1, s3, 3
    s_lshl_b32 s64, s9, 8
    s_lshl_b32 s65, s1, 6
    s_add_u32 s64, s64, s65
    s_add_u32 s64, s64, 12288
    s_cmp_ge_u32 s8, 24
    s_cselect_b32 s65, 2048, 0
    s_add_u32 s64, s64, s65
    s_and_b32 s65, s8, 3
    s_lshl_b32 s65, s65, 13
    s_add_u32 s72, s64, s65
    s_lshl_b32 s64, s8, 5
    s_add_u32 s64, s64, 10240
    s_and_b32 s65, s9, 3
    s_lshl_b32 s65, s65, 13
    s_add_u32 s73, s64, s65
    s_lshl_b32 s0, s8, 11
    s_add_u32 s0, s0, 65536
    v_lshlrev_b32 v25, 2, v0
    s_lshl_b32 s64, s9, 18
    s_lshl_b32 s65, s1, 16
    s_add_u32 s64, s64, s65
    s_lshl_b32 s65, s8, 7
    s_add_u32 s64, s64, s65
    s_add_u32 s68, s64, 3145728
    v_lshrrev_b32 v28, 3, v0
    v_lshlrev_b32 v28, 12, v28
    v_bfe_u32 v19, v0, 1, 2
    v_lshl_add_u32 v28, v19, 4, v28
    v_and_b32 v19, 1, v0
    v_lshl_add_u32 v28, v19, 6, v28
    v_add_u32 v29, 31744, v28
    s_lshl_b32 s75, s1, 11
    s_add_u32 s75, s75, 131072
    v_bfe_u32 v26, v0, 2, 2
    v_lshlrev_b32 v26, 7, v26
    v_lshrrev_b32 v19, 4, v0
    v_lshl_add_u32 v26, v19, 5, v26
    v_and_b32 v19, 3, v0
    v_lshl_add_u32 v26, v19, 3, v26
    v_add_u32 v26, s75, v26
    v_and_b32 v27, 7, v0
    s_lshl_b32 s64, s1, 1
    v_xor_b32 v27, s64, v27
    v_lshlrev_b32 v27, 4, v27
    v_lshl_add_u32 v27, v0, 7, v27
    v_add_u32 v27, 148480, v27
    v_xor_b32 v30, 16, v27
    ds_read_b128 v[20:23], v12 offset:208
    s_waitcnt lgkmcnt(0)
    v_or3_b32 v17, v20, v21, v22
    v_or_b32 v17, v17, v23
    s_nop 0
    v_readfirstlane_b32 s69, v17
    s_nop 0
    s_cmp_eq_u32 s69, 0
    s_cbranch_scc0 Lslow_90
Lret_91:
    v_add_u32 v31, 157696, v25
    s_cmp_lg_u32 s3, 4
    s_cbranch_scc1 L_ng1
    s_mov_b32 s66, s13
    s_mov_b32 s67, s13
    s_mov_b32 s70, 524288
Lsp_93:
    s_buffer_load_dwordx8 s[16:23], s[56:59], s73 glc
    s_waitcnt lgkmcnt(0)
    s_xor_b64 s[16:17], s[16:17], s[66:67]
    s_xor_b64 s[18:19], s[18:19], s[66:67]
    s_xor_b64 s[20:21], s[20:21], s[66:67]
    s_xor_b64 s[22:23], s[22:23], s[66:67]
    s_or_b64 s[16:17], s[16:17], s[18:19]
    s_or_b64 s[16:17], s[16:17], s[20:21]
    s_or_b64 s[16:17], s[16:17], s[22:23]
    s_cbranch_scc0 Lsd_94
    s_sleep 5
    s_sub_u32 s70, s70, 1
    s_cmp_lg_u32 s70, 0
    s_cbranch_scc1 Lsp_93
Lsd_94:
L_ng1:
    s_mov_b32 s66, s13
    s_mov_b32 s67, s13
    s_mov_b32 s70, 524288
Lsp_95:
    s_buffer_load_dwordx16 s[16:31], s[56:59], s72 glc
    s_waitcnt lgkmcnt(0)
    s_xor_b64 s[16:17], s[16:17], s[66:67]
    s_xor_b64 s[18:19], s[18:19], s[66:67]
    s_xor_b64 s[20:21], s[20:21], s[66:67]
    s_xor_b64 s[22:23], s[22:23], s[66:67]
    s_xor_b64 s[24:25], s[24:25], s[66:67]
    s_xor_b64 s[26:27], s[26:27], s[66:67]
    s_xor_b64 s[28:29], s[28:29], s[66:67]
    s_xor_b64 s[30:31], s[30:31], s[66:67]
    s_or_b64 s[16:17], s[16:17], s[18:19]
    s_or_b64 s[16:17], s[16:17], s[20:21]
    s_or_b64 s[16:17], s[16:17], s[22:23]
    s_or_b64 s[16:17], s[16:17], s[24:25]
    s_or_b64 s[16:17], s[16:17], s[26:27]
    s_or_b64 s[16:17], s[16:17], s[28:29]
    s_or_b64 s[16:17], s[16:17], s[30:31]
    s_cbranch_scc0 Lsd_96
    s_sleep 5
    s_sub_u32 s70, s70, 1
    s_cmp_lg_u32 s70, 0
    s_cbranch_scc1 Lsp_95
Lsd_96:
    s_mov_b32 m0, s75
    s_nop 0
    buffer_load_dwordx4 v28, s[56:59], s68 offen offset:0 sc1 lds
    buffer_load_dwordx4 v29, s[56:59], s68 offen offset:1024 sc1 lds
    s_cmp_lg_u32 s3, 4
    s_cbranch_scc1 L_ng2
    buffer_load_dword v120, v25, s[56:59], s0 offen offset:0 sc1
    buffer_load_dword v121, v25, s[56:59], s0 offen offset:256 sc1
    buffer_load_dword v122, v25, s[56:59], s0 offen offset:512 sc1
    buffer_load_dword v123, v25, s[56:59], s0 offen offset:768 sc1
    buffer_load_dword v124, v25, s[56:59], s0 offen offset:1024 sc1
    buffer_load_dword v125, v25, s[56:59], s0 offen offset:1280 sc1
    buffer_load_dword v126, v25, s[56:59], s0 offen offset:1536 sc1
    buffer_load_dword v127, v25, s[56:59], s0 offen offset:1792 sc1
    s_waitcnt vmcnt(0)
    v_add_f32 v120, v120, v121
    v_add_f32 v122, v122, v123
    v_add_f32 v124, v124, v125
    v_add_f32 v126, v126, v127
    v_add_f32 v120, v120, v122
    v_add_f32 v124, v124, v126
    v_add_f32 v120, v120, v124
    v_cvt_pk_bf16_f32 v120, v120, v120
    v_lshlrev_b32 v120, 16, v120
    v_mul_f32 v120, 0xbfb8aa3b, v120
    v_exp_f32 v120, v120
    s_nop 0
    v_add_f32 v120, 1.0, v120
    v_rcp_f32 v120, v120
    s_nop 0
    v_cvt_pk_bf16_f32 v120, v120, v120
    v_lshlrev_b32 v10, 16, v120
    v_sub_f32 v121, 1.0, v10
    v_cvt_pk_bf16_f32 v121, v121, v121
    v_lshlrev_b32 v121, 16, v121
    ds_write_b32 v31, v10
    ds_write_b32 v31, v121 offset:5760
    v_mov_b32 v17, 1
    ds_write_b32 v12, v17 offset:340
L_ng2:
    v_lshlrev_b32 v18, 4, v0
    v_add_u32 v18, 12288, v18
    s_cmp_lg_u32 s2, 248
    s_cbranch_scc1 L_ne
    s_cmp_lg_u32 s3, 7
    s_cbranch_scc1 L_ne
    ds_read_b128 v[20:23], v12 offset:240
    s_waitcnt lgkmcnt(0)
    v_or3_b32 v17, v20, v21, v22
    v_or_b32 v17, v17, v23
    s_nop 0
    v_readfirstlane_b32 s69, v17
    s_nop 0
    s_cmp_eq_u32 s69, 0
    s_cbranch_scc0 Lslow_97
Lret_98:
    buffer_load_dwordx4 v[140:143], v18, s[56:59], 0 offen offset:0 sc1
    buffer_load_dwordx4 v[144:147], v18, s[56:59], 0 offen offset:1024 sc1
    buffer_load_dwordx4 v[148:151], v18, s[56:59], 0 offen offset:2048 sc1
    buffer_load_dwordx4 v[152:155], v18, s[56:59], 0 offen offset:3072 sc1
L_ne:
    ds_read_b32 v20, v12 offset:340
    s_waitcnt lgkmcnt(0)
    v_readfirstlane_b32 s69, v20
    s_nop 0
    s_cmp_ge_u32 s69, 1
    s_cbranch_scc0 Lslow_100
Lret_101:
    ds_read_b32 v10, v31
    s_waitcnt vmcnt(0)
    ds_read_b64_tr_b16 v[40:41], v26 offset:0
    ds_read_b64_tr_b16 v[42:43], v26 offset:512
    ds_read_b64_tr_b16 v[44:45], v26 offset:1024
    ds_read_b64_tr_b16 v[46:47], v26 offset:1536
    s_waitcnt lgkmcnt(0)
    v_lshlrev_b32 v80, 16, v40
    v_and_b32 v81, 0xffff0000, v40
    v_lshlrev_b32 v82, 16, v41
    v_and_b32 v83, 0xffff0000, v41
    v_lshlrev_b32 v84, 16, v42
    v_and_b32 v85, 0xffff0000, v42
    v_lshlrev_b32 v86, 16, v43
    v_and_b32 v87, 0xffff0000, v43
    v_mul_f32 v80, v10, v80
    v_mul_f32 v81, v10, v81
    v_mul_f32 v82, v10, v82
    v_mul_f32 v83, v10, v83
    v_mul_f32 v84, v10, v84
    v_mul_f32 v85, v10, v85
    v_mul_f32 v86, v10, v86
    v_mul_f32 v87, v10, v87
    v_cvt_pk_bf16_f32 v60, v80, v81
    v_cvt_pk_bf16_f32 v61, v82, v83
    v_cvt_pk_bf16_f32 v62, v84, v85
    v_cvt_pk_bf16_f32 v63, v86, v87
    ds_write_b128 v27, v[60:63]
    v_lshlrev_b32 v88, 16, v44
    v_and_b32 v89, 0xffff0000, v44
    v_lshlrev_b32 v90, 16, v45
    v_and_b32 v91, 0xffff0000, v45
    v_lshlrev_b32 v92, 16, v46
    v_and_b32 v93, 0xffff0000, v46
    v_lshlrev_b32 v94, 16, v47
    v_and_b32 v95, 0xffff0000, v47
    v_mul_f32 v88, v10, v88
    v_mul_f32 v89, v10, v89
    v_mul_f32 v90, v10, v90
    v_mul_f32 v91, v10, v91
    v_mul_f32 v92, v10, v92
    v_mul_f32 v93, v10, v93
    v_mul_f32 v94, v10, v94
    v_mul_f32 v95, v10, v95
    v_cvt_pk_bf16_f32 v64, v88, v89
    v_cvt_pk_bf16_f32 v65, v90, v91
    v_cvt_pk_bf16_f32 v66, v92, v93
    v_cvt_pk_bf16_f32 v67, v94, v95
    ds_write_b128 v30, v[64:67]
    s_cmp_lg_u32 s2, 248
    s_cbranch_scc1 L_A_end
    s_cmp_lg_u32 s3, 7
    s_cbranch_scc1 L_A_end
    v_xor_b32 v20, s13, v140
    v_xor_b32 v141, s13, v141
    v_or_b32 v20, v20, v141
    v_xor_b32 v142, s13, v142
    v_or_b32 v20, v20, v142
    v_xor_b32 v143, s13, v143
    v_or_b32 v20, v20, v143
    v_xor_b32 v144, s13, v144
    v_or_b32 v20, v20, v144
    v_xor_b32 v145, s13, v145
    v_or_b32 v20, v20, v145
    v_xor_b32 v146, s13, v146
    v_or_b32 v20, v20, v146
    v_xor_b32 v147, s13, v147
    v_or_b32 v20, v20, v147
    v_xor_b32 v148, s13, v148
    v_or_b32 v20, v20, v148
    v_xor_b32 v149, s13, v149
    v_or_b32 v20, v20, v149
    v_xor_b32 v150, s13, v150
    v_or_b32 v20, v20, v150
    v_xor_b32 v151, s13, v151
    v_or_b32 v20, v20, v151
    v_xor_b32 v152, s13, v152
    v_or_b32 v20, v20, v152
    v_xor_b32 v153, s13, v153
    v_or_b32 v20, v20, v153
    v_xor_b32 v154, s13, v154
    v_or_b32 v20, v20, v154
    v_xor_b32 v155, s13, v155
    v_or_b32 v20, v20, v155
    v_cmp_ne_u32 vcc, 0, v20
    s_nop 1
    s_cbranch_vccnz Lgs_103
Lgr_104:
    s_mov_b32 s64, 0
    v_mov_b32 v20, s13
    s_mov_b64 exec, 1
    buffer_store_dword v20, off, s[56:59], s64 sc1
    s_mov_b64 exec, -1
L_A_end:
    s_mov_b32 s60, s42
    s_mov_b32 s61, s43
    s_mov_b32 s62, 0x200000
    s_mov_b32 s63, 0x20000
    s_branch L_tail
Lslow_81:
    s_mov_b32 s70, 524288
Lspin_83:
    ds_read_b32 v20, v16 offset:0
    s_waitcnt lgkmcnt(0)
    v_readfirstlane_b32 s69, v20
    s_nop 0
    s_cmp_ge_u32 s69, 1
    s_cbranch_scc1 Lret_82
    s_sleep 1
    s_sub_u32 s70, s70, 1
    s_cmp_lg_u32 s70, 0
    s_cbranch_scc1 Lspin_83
    s_branch Lret_82
Lslow_84:
    s_mov_b32 s70, 524288
Lspin_86:
    ds_read_b128 v[16:19], v12 offset:160
    s_waitcnt lgkmcnt(0)
    v_or3_b32 v21, v16, v17, v18
    v_or_b32 v21, v21, v19
    s_nop 0
    v_readfirstlane_b32 s69, v21
    s_nop 0
    s_cmp_eq_u32 s69, 0
    s_cbranch_scc1 Lret_85
    s_sleep 2
    s_sub_u32 s70, s70, 1
    s_cmp_lg_u32 s70, 0
    s_cbranch_scc1 Lspin_86
    s_branch Lret_85
Lslow_87:
    s_mov_b32 s70, 524288
Lspin_89:
    ds_read_b32 v16, v12 offset:224
    s_waitcnt lgkmcnt(0)
    v_readfirstlane_b32 s69, v16
    s_nop 0
    s_cmp_eq_u32 s69, 0
    s_cbranch_scc1 Lret_88
    s_sleep 2
    s_sub_u32 s70, s70, 1
    s_cmp_lg_u32 s70, 0
    s_cbranch_scc1 Lspin_89
    s_branch Lret_88
Lslow_90:
    s_mov_b32 s70, 524288
Lspin_92:
    ds_read_b128 v[20:23], v12 offset:208
    s_waitcnt lgkmcnt(0)
    v_or3_b32 v17, v20, v21, v22
    v_or_b32 v17, v17, v23
    s_nop 0
    v_readfirstlane_b32 s69, v17
    s_nop 0
    s_cmp_eq_u32 s69, 0
    s_cbranch_scc1 Lret_91
    s_sleep 2
    s_sub_u32 s70, s70, 1
    s_cmp_lg_u32 s70, 0
    s_cbranch_scc1 Lspin_92
    s_branch Lret_91
Lslow_97:
    s_mov_b32 s70, 524288
Lspin_99:
    ds_read_b128 v[20:23], v12 offset:240
    s_waitcnt lgkmcnt(0)
    v_or3_b32 v17, v20, v21, v22
    v_or_b32 v17, v17, v23
    s_nop 0
    v_readfirstlane_b32 s69, v17
    s_nop 0
    s_cmp_eq_u32 s69, 0
    s_cbranch_scc1 Lret_98
    s_sleep 4
    s_sub_u32 s70, s70, 1
    s_cmp_lg_u32 s70, 0
    s_cbranch_scc1 Lspin_99
    s_branch Lret_98
Lslow_100:
    s_mov_b32 s70, 524288
Lspin_102:
    ds_read_b32 v20, v12 offset:340
    s_waitcnt lgkmcnt(0)
    v_readfirstlane_b32 s69, v20
    s_nop 0
    s_cmp_ge_u32 s69, 1
    s_cbranch_scc1 Lret_101
    s_sleep 1
    s_sub_u32 s70, s70, 1
    s_cmp_lg_u32 s70, 0
    s_cbranch_scc1 Lspin_102
    s_branch Lret_101
Lgs_103:
    s_mov_b32 s70, 524288
Lgl_105:
    s_sleep 4
    buffer_load_dwordx4 v[140:143], v18, s[56:59], 0 offen offset:0 sc1
    buffer_load_dwordx4 v[144:147], v18, s[56:59], 0 offen offset:1024 sc1
    buffer_load_dwordx4 v[148:151], v18, s[56:59], 0 offen offset:2048 sc1
    buffer_load_dwordx4 v[152:155], v18, s[56:59], 0 offen offset:3072 sc1
    s_waitcnt vmcnt(0)
    v_xor_b32 v20, s13, v140
    v_xor_b32 v141, s13, v141
    v_or_b32 v20, v20, v141
    v_xor_b32 v142, s13, v142
    v_or_b32 v20, v20, v142
    v_xor_b32 v143, s13, v143
    v_or_b32 v20, v20, v143
    v_xor_b32 v144, s13, v144
    v_or_b32 v20, v20, v144
    v_xor_b32 v145, s13, v145
    v_or_b32 v20, v20, v145
    v_xor_b32 v146, s13, v146
    v_or_b32 v20, v20, v146
    v_xor_b32 v147, s13, v147
    v_or_b32 v20, v20, v147
    v_xor_b32 v148, s13, v148
    v_or_b32 v20, v20, v148
    v_xor_b32 v149, s13, v149
    v_or_b32 v20, v20, v149
    v_xor_b32 v150, s13, v150
    v_or_b32 v20, v20, v150
    v_xor_b32 v151, s13, v151
    v_or_b32 v20, v20, v151
    v_xor_b32 v152, s13, v152
    v_or_b32 v20, v20, v152
    v_xor_b32 v153, s13, v153
    v_or_b32 v20, v20, v153
    v_xor_b32 v154, s13, v154
    v_or_b32 v20, v20, v154
    v_xor_b32 v155, s13, v155
    v_or_b32 v20, v20, v155
    v_cmp_ne_u32 vcc, 0, v20
    s_nop 1
    s_cbranch_vccz Lgr_104
    s_sub_u32 s70, s70, 1
    s_cmp_lg_u32 s70, 0
    s_cbranch_scc1 Lgl_105
    s_branch Lgr_104
L_exit:
    s_endpgm
.section .rodata,"a"
.p2align 6
.amdhsa_kernel gated_mix__ssm_conv_s4__dense_activation_relu__prompt_kernel
  .amdhsa_next_free_vgpr 256
  .amdhsa_next_free_sgpr 102
  .amdhsa_accum_offset 256
  .amdhsa_group_segment_fixed_size 0
  .amdhsa_kernarg_size 128
  .amdhsa_user_sgpr_count 2
  .amdhsa_user_sgpr_kernarg_segment_ptr 1
  .amdhsa_system_sgpr_workgroup_id_x 1
.end_amdhsa_kernel
```
